```python
import torch

def _softmax(x, axis=-1):
    return torch.softmax(x, dim=axis)
def _gelu(x):
    return torch.nn.functional.gelu(x, approximate="tanh")
def _silu(x):
    return torch.nn.functional.silu(x)
def _sigmoid(x):
    return torch.sigmoid(x)
def _layernorm(x, axis=-1, eps=1e-5):
    m = x.mean(dim=axis, keepdim=True)
    v = x.var(dim=axis, keepdim=True, unbiased=False)
    return (x - m) / torch.sqrt(v + eps)
def _scatter_add(tgt, idx, src, axis=0):
    return tgt.clone().index_add_(axis, idx, src)
def _segment_sum(src, seg, n):
    out = torch.zeros((n,) + src.shape[1:], dtype=src.dtype)
    return out.index_add_(0, seg, src)
def _pad(x, pw):
    flat = tuple(v for pair in reversed(pw) for v in pair)
    return torch.nn.functional.pad(x, flat)

kernel_name = 'concat_heads__linear_kernel_hedgehog__linear_kernel_hedgehog__prompt'

def setup_inputs():

    _w = (lambda a: (lambda t: t.to(torch.bfloat16) if t.is_floating_point() else t)(torch.as_tensor(a)))
    def _A_setup():
        B, S, D, H = 1, 2048, 512, 32
        Dh = D // H
        return {
            "x": _w((lambda *s: torch.randn(*s, dtype=torch.bfloat16) * 0.4)(B, S, D)),
            "wqkv": _w((lambda *s: torch.randn(*s, dtype=torch.bfloat16) * 0.4)(D, 3 * D)),
            "w_phi": _w((lambda *s: torch.randn(*s, dtype=torch.bfloat16) * 0.4)(H, Dh, Dh) * (Dh ** -0.5)),
            "wo": _w((lambda *s: torch.randn(*s, dtype=torch.bfloat16) * 0.05)(D, D)),
        }
    _A_in = _A_setup()

    def _B_setup():
        B, S, D, H = 1, 2048, 512, 32
        Dh = D // H
        return {
            "x": _w((lambda *s: torch.randn(*s, dtype=torch.bfloat16) * 0.4)(B, S, D)),
            "wqkv": _w((lambda *s: torch.randn(*s, dtype=torch.bfloat16) * 0.4)(D, 3 * D)),
            "w_phi": _w((lambda *s: torch.randn(*s, dtype=torch.bfloat16) * 0.4)(H, Dh, Dh) * (Dh ** -0.5)),
            "wo": _w((lambda *s: torch.randn(*s, dtype=torch.bfloat16) * 0.05)(D, D)),
        }
    _B_in = _B_setup()

    return {
        "A_x": _A_in["x"],
        "A_wqkv": _A_in["wqkv"],
        "A_w_phi": _A_in["w_phi"],
        "A_wo": _A_in["wo"],
        "B_x": _B_in["x"],
        "B_wqkv": _B_in["wqkv"],
        "B_w_phi": _B_in["w_phi"],
        "B_wo": _B_in["wo"],
    }

def reference(A_x, A_wqkv, A_w_phi, A_wo, B_x, B_wqkv, B_w_phi, B_wo):
    def _A_ref(x, wqkv, w_phi, wo):
        B, S, D = x.shape
        H = 32; Dh = D // H
        qkv = (lambda x, *d: x.permute(*d))((x @ wqkv).reshape(B, S, 3, H, Dh), 2, 0, 3, 1, 4)
        q, k, v = qkv[0], qkv[1], qkv[2]
        pq = torch.einsum("bhsd,hdf->bhsf", q, w_phi)
        pk = torch.einsum("bhsd,hdf->bhsf", k, w_phi)
        phi_q = torch.concatenate([_softmax(pq, axis=-1), _softmax(-pq, axis=-1)], axis=-1)
        phi_k = torch.concatenate([_softmax(pk, axis=-1), _softmax(-pk, axis=-1)], axis=-1)
        kv = torch.einsum("bhsf,bhsd->bhfd", phi_k, v)
        z  = torch.einsum("bhsf->bhf", phi_k)
        num = torch.einsum("bhqf,bhfd->bhqd", phi_q, kv)
        den = torch.einsum("bhqf,bhf->bhq", phi_q, z)[..., None] + 1e-6
        o = num / den
        return (lambda x, *d: x.permute(*d))(o, 0, 2, 1, 3).reshape(B, S, D) @ wo

    def _B_ref(x, wqkv, w_phi, wo):
        B, S, D = x.shape
        H = 32; Dh = D // H
        qkv = (lambda x, *d: x.permute(*d))((x @ wqkv).reshape(B, S, 3, H, Dh), 2, 0, 3, 1, 4)
        q, k, v = qkv[0], qkv[1], qkv[2]
        pq = torch.einsum("bhsd,hdf->bhsf", q, w_phi)
        pk = torch.einsum("bhsd,hdf->bhsf", k, w_phi)
        phi_q = torch.concatenate([_softmax(pq, axis=-1), _softmax(-pq, axis=-1)], axis=-1)
        phi_k = torch.concatenate([_softmax(pk, axis=-1), _softmax(-pk, axis=-1)], axis=-1)
        kv = torch.einsum("bhsf,bhsd->bhfd", phi_k, v)
        z  = torch.einsum("bhsf->bhf", phi_k)
        num = torch.einsum("bhqf,bhfd->bhqd", phi_q, kv)
        den = torch.einsum("bhqf,bhf->bhq", phi_q, z)[..., None] + 1e-6
        o = num / den
        return (lambda x, *d: x.permute(*d))(o, 0, 2, 1, 3).reshape(B, S, D) @ wo

    a = _A_ref(A_x, A_wqkv, A_w_phi, A_wo)
    b = _B_ref(B_x, B_wqkv, B_w_phi, B_wo)
    return torch.concatenate([a, b], axis=-1)
```

```asm
; @launch grid=(256,1,1) block=(512,1,1) lds=163840
.amdgcn_target "amdgcn-amd-amdhsa--gfx950"
.text
.globl concat_heads__linear_kernel_hedgehog__linear_kernel_hedgehog__prompt_kernel
.p2align 8
.type concat_heads__linear_kernel_hedgehog__linear_kernel_hedgehog__prompt_kernel,@function
concat_heads__linear_kernel_hedgehog__linear_kernel_hedgehog__prompt_kernel:
K_start:
    s_cmp_ge_u32 s2, 256
    s_cbranch_scc1 K_end
    s_and_b32 s3, s2, 7
    s_lshr_b32 s4, s2, 3
    s_lshr_b32 s5, s3, 2
    s_lshl_b32 s8, s5, 5
    s_load_dwordx2 s[20:21], s[0:1], s8
    s_add_u32 s10, s8, 8
    s_load_dwordx2 s[24:25], s[0:1], s10
    s_add_u32 s10, s8, 16
    s_load_dwordx4 s[16:19], s[0:1], s10
    s_load_dwordx4 s[40:43], s[0:1], 64
    s_load_dwordx2 s[44:45], s[0:1], 80
    v_lshrrev_b32 v1, 6, v0
    v_and_b32 v2, 63, v0
    v_readfirstlane_b32 s9, v1
    s_and_b32 s6, s4, 3
    s_lshr_b32 s7, s4, 2
    s_lshl_b32 s67, s6, 1
    s_add_u32 s66, s6, s7
    s_and_b32 s66, s66, 1
    s_and_b32 s8, s3, 3
    s_lshl_b32 s8, s8, 1
    s_or_b32 s66, s66, s8
    s_and_b32 s8, s3, 3
    s_lshl_b32 s8, s8, 2
    s_add_u32 s6, s6, s8
    s_lshl_b32 s46, s7, 7
    s_cmp_ge_u32 s9, 4
    s_cbranch_scc1 K_ld
    s_getpc_b64 s[50:51]
K_pc:
    s_sub_u32 s50, s50, K_pc-K_start
    s_subb_u32 s51, s51, 0
    v_lshlrev_b32 v10, 7, v0
    v_min_u32 v10, K_end-K_start, v10
    global_load_dword v8, v10, s[50:51]
    s_branch K_kv
K_ld:
    s_setprio 3
    s_sub_u32 s10, s9, 4
    v_lshrrev_b32 v3, 3, v2
    v_and_b32 v12, 7, v2
    v_lshrrev_b32 v10, 1, v3
    v_xor_b32 v11, v12, v10
    v_lshlrev_b32 v11, 4, v11
    v_lshl_add_u32 v4, v3, 10, v11
    v_xor_b32 v5, 64, v4
    v_add_u32 v6, 14336, v4
    v_add_u32 v7, 21504, v5
    v_add_u32 v5, 7168, v5
    v_and_b32 v10, 1, v10
    v_mul_u32_u24 v13, 3072, v3
    v_lshlrev_b32 v11, 1, v10
    v_xor_b32 v11, v12, v11
    v_lshl_add_u32 v125, v11, 4, v13
    v_xor_b32 v126, 64, v125
    s_lshl_b32 s36, s6, 17
    s_lshl_b32 s8, s10, 15
    s_add_u32 s36, s36, s8
    s_mul_i32 s8, s10, 49152
    s_add_u32 s37, s46, s8
    s_add_u32 s37, s37, 1024
    s_lshl_b32 s38, s10, 13
    s_mov_b32 s22, 0x200000
    s_mov_b32 s23, 0x20000
    s_mov_b32 s26, 0x180000
    s_mov_b32 s27, 0x20000
    s_xor_b32 s39, s66, 0
    s_lshl_b32 s51, s39, 7
    s_add_u32 s51, s51, s36
    s_add_u32 m0, s38, 0
    s_mul_i32 s52, s39, 196608
    s_waitcnt lgkmcnt(0)
    buffer_load_dwordx4 v4, s[20:23], s51 offen offset:0 lds
    buffer_load_dwordx4 v5, s[20:23], s51 offen offset:1024 lds
    buffer_load_dwordx4 v6, s[20:23], s51 offen offset:2048 lds
    buffer_load_dwordx4 v7, s[20:23], s51 offen offset:3072 lds
    s_add_u32 s52, s52, s37
    s_add_u32 m0, s38, 4096
    s_add_u32 s53, s52, 22528
    buffer_load_dwordx4 v125, s[24:27], s52 offen offset:0 lds
    buffer_load_dwordx4 v125, s[24:27], s52 offen offset:1024 lds
    buffer_load_dwordx4 v126, s[24:27], s53 offen offset:2048 lds
    buffer_load_dwordx4 v126, s[24:27], s53 offen offset:3072 lds
    v_lshlrev_b32 v14, 4, v2
    s_mov_b32 s32, s16
    s_mov_b32 s33, s17
    s_mov_b32 s34, 0x4000
    s_mov_b32 s35, 0x20000
    s_and_b32 s8, s10, 1
    s_lshl_b32 s8, s8, 10
    s_add_u32 m0, s8, 161792
    s_lshl_b32 s47, s7, 11
    s_add_u32 s8, s8, s47
    buffer_load_dwordx4 v14, s[32:35], s8 offen lds
    s_mov_b32 s60, s42
    s_mov_b32 s61, s43
    s_mov_b32 s62, 0x100
    s_mov_b32 s63, 0x20000
    v_mov_b32 v15, 0
    s_or_b32 s8, s2, s10
    s_cmp_lg_u32 s8, 0
    s_cbranch_scc1 K_nolead
    s_memrealtime s[48:49]
    s_waitcnt lgkmcnt(0)
    s_or_b32 s48, s48, 1
    v_mov_b32 v112, s48
    s_mov_b64 exec, 1
    buffer_store_dword v112, v15, s[60:63], 0 offen sc1
    s_mov_b64 exec, -1
K_nolead:
    s_xor_b32 s39, s66, 1
    s_lshl_b32 s51, s39, 7
    s_add_u32 s51, s51, s36
    s_add_u32 m0, s38, 32768
    s_mul_i32 s52, s39, 196608
    buffer_load_dwordx4 v4, s[20:23], s51 offen offset:0 lds
    buffer_load_dwordx4 v5, s[20:23], s51 offen offset:1024 lds
    buffer_load_dwordx4 v6, s[20:23], s51 offen offset:2048 lds
    buffer_load_dwordx4 v7, s[20:23], s51 offen offset:3072 lds
    s_add_u32 s52, s52, s37
    s_add_u32 m0, s38, 36864
    s_add_u32 s53, s52, 22528
    buffer_load_dwordx4 v125, s[24:27], s52 offen offset:0 lds
    buffer_load_dwordx4 v125, s[24:27], s52 offen offset:1024 lds
    buffer_load_dwordx4 v126, s[24:27], s53 offen offset:2048 lds
    buffer_load_dwordx4 v126, s[24:27], s53 offen offset:3072 lds
    v_lshlrev_b32 v11, 2, v10
    v_xor_b32 v11, v12, v11
    v_lshl_add_u32 v8, v11, 4, v13
    v_lshrrev_b32 v9, 5, v2
    s_mov_b32 s54, 0x3fb8aa3b
    s_mov_b32 s55, 0x3fb8aa3b
    s_mov_b32 s56, 0xbfb8aa3b
    s_mov_b32 s28, s44
    s_mov_b32 s29, s45
    s_mov_b32 s30, 0x10000000
    s_mov_b32 s31, 0x20000
    v_and_b32 v3, 31, v2
    v_bfe_u32 v10, v2, 1, 3
    v_or_b32 v11, 0, v9
    v_xor_b32 v11, v11, v10
    v_lshlrev_b32 v11, 4, v11
    v_lshl_add_u32 v11, v3, 7, v11
    v_add_u32 v16, s38, v11
    v_add_u32 v20, 65536, v16
    v_add_u32 v118, 131072, v16
    v_or_b32 v11, 2, v9
    v_xor_b32 v11, v11, v10
    v_lshlrev_b32 v11, 4, v11
    v_lshl_add_u32 v11, v3, 7, v11
    v_add_u32 v17, s38, v11
    v_add_u32 v21, 65536, v17
    v_add_u32 v119, 131072, v17
    v_or_b32 v11, 4, v9
    v_xor_b32 v11, v11, v10
    v_lshlrev_b32 v11, 4, v11
    v_lshl_add_u32 v11, v3, 7, v11
    v_add_u32 v18, s38, v11
    v_add_u32 v22, 65536, v18
    v_add_u32 v120, 131072, v18
    v_or_b32 v11, 6, v9
    v_xor_b32 v11, v11, v10
    v_lshlrev_b32 v11, 4, v11
    v_lshl_add_u32 v11, v3, 7, v11
    v_add_u32 v19, s38, v11
    v_add_u32 v23, 65536, v19
    v_add_u32 v121, 131072, v19
    v_bfe_u32 v10, v2, 2, 2
    v_lshl_add_u32 v10, v9, 2, v10
    v_lshlrev_b32 v10, 5, v10
    v_bfe_u32 v11, v2, 4, 1
    v_lshl_add_u32 v10, v11, 4, v10
    v_bfe_u32 v11, v2, 1, 1
    v_lshl_add_u32 v13, v11, 3, v10
    v_add_u32 v13, 161792, v13
    v_and_b32 v10, 7, v2
    v_bfe_u32 v11, v2, 4, 1
    v_lshlrev_b32 v11, 1, v11
    v_xor_b32 v10, v10, v11
    v_lshlrev_b32 v10, 4, v10
    v_lshrrev_b32 v11, 3, v2
    v_lshl_add_u32 v113, v11, 10, v10
    v_mov_b32 v114, 6144
    v_bfe_u32 v10, v2, 4, 1
    v_lshlrev_b32 v10, 1, v10
    v_bfe_u32 v11, v2, 1, 1
    v_or_b32 v10, v10, v11
    v_bfe_u32 v11, v2, 3, 1
    v_lshlrev_b32 v11, 2, v11
    v_xor_b32 v10, v10, v11
    v_lshlrev_b32 v10, 4, v10
    v_and_b32 v11, 1, v2
    v_lshl_add_u32 v10, v11, 3, v10
    v_bfe_u32 v11, v2, 2, 2
    v_lshl_add_u32 v10, v11, 7, v10
    v_lshl_add_u32 v10, v9, 10, v10
    v_add_u32 v115, 98304, v10
    v_xor_b32 v116, 64, v115
    v_add_u32 v117, 4096, v14
    v_bfe_u32 v12, v2, 2, 1
    v_mul_u32_u24 v12, 0x8000, v12
    v_lshl_or_b32 v12, v12, 16, v12
    s_lshl_b32 s68, s66, 3
    s_lshl_b32 s64, s67, 3
    s_add_u32 s64, s64, s10
    s_lshl_b32 s65, s67, 3
    s_add_u32 s65, s65, s10
    s_lshl_b32 s8, s5, 6
    s_lshl_b32 s59, s6, 2
    s_add_u32 s8, s8, s59
    s_add_u32 s8, s8, s10
    s_lshl_b32 s50, s8, 15
    s_lshl_b32 s58, s8, 10
    s_lshl_b32 s8, s7, 12
    s_add_u32 s50, s50, s8
    s_add_u32 s50, s50, 0x1000000
    s_add_u32 s58, s58, s46
    s_add_u32 s58, s58, 0x300000
    s_getreg_b32 s11, hwreg(HW_REG_XCC_ID, 0, 4)
    s_lshl_b32 s11, s11, 1
    s_lshl_b32 s8, s5, 4
    s_add_u32 s8, s8, s6
    s_lshl_b32 s47, s8, 10
    s_add_u32 s47, s47, 0x380000
    s_add_u32 s69, s47, s46
    v_and_b32 v123, 7, v2
    v_lshlrev_b32 v123, 7, v123
    v_lshrrev_b32 v10, 3, v2
    v_min_u32 v10, 1, v10
    v_lshl_or_b32 v123, v10, 30, v123
    v_lshrrev_b32 v10, 4, v2
    v_lshlrev_b32 v104, 12, v10
    v_and_b32 v11, 15, v2
    v_lshl_add_u32 v104, v11, 3, v104
    v_lshlrev_b32 v105, 11, v10
    v_lshl_add_u32 v105, v11, 3, v105
    v_lshrrev_b32 v10, 1, v10
    v_lshl_or_b32 v105, v10, 30, v105
    v_mov_b32 v106, 0
    v_mov_b32 v107, 0
    s_lshl_b32 s8, s5, 5
    s_lshl_b32 s57, s7, 2
    s_add_u32 s8, s8, s57
    s_add_u32 s8, s8, s10
    s_lshl_b32 s12, s8, 15
    s_lshl_b32 s14, s8, 12
    s_lshl_b32 s8, s6, 7
    s_add_u32 s12, s12, s8
    s_add_u32 s12, s12, 0x400000
    s_add_u32 s13, s12, 16384
    s_add_u32 s14, s14, s8
    s_add_u32 s14, s14, 0x200000
    s_xor_b32 s39, s66, 2
    s_lshl_b32 s51, s39, 7
    s_add_u32 s51, s51, s36
    s_add_u32 m0, s38, 65536
    s_mul_i32 s52, s39, 196608
    buffer_load_dwordx4 v4, s[20:23], s51 offen offset:0 lds
    buffer_load_dwordx4 v5, s[20:23], s51 offen offset:1024 lds
    buffer_load_dwordx4 v6, s[20:23], s51 offen offset:2048 lds
    buffer_load_dwordx4 v7, s[20:23], s51 offen offset:3072 lds
    s_waitcnt vmcnt(12)
    s_barrier
    ds_read_b128 v[128:131], v16 offset:0
    ds_read_b128 v[132:135], v17 offset:0
    ds_read_b128 v[136:139], v18 offset:0
    ds_read_b128 v[140:143], v19 offset:0
    ds_read_b64_tr_b16 v[24:25], v13 offset:0
    ds_read_b64_tr_b16 v[26:27], v13 offset:256
    ds_read_b64_tr_b16 v[28:29], v13 offset:512
    ds_read_b64_tr_b16 v[30:31], v13 offset:768
    ds_read_b64_tr_b16 v[32:33], v13 offset:1024
    ds_read_b64_tr_b16 v[34:35], v13 offset:1280
    ds_read_b64_tr_b16 v[36:37], v13 offset:1536
    ds_read_b64_tr_b16 v[38:39], v13 offset:1792
    s_add_u32 s52, s52, s37
    s_add_u32 m0, s38, 69632
    s_add_u32 s53, s52, 22528
    buffer_load_dwordx4 v125, s[24:27], s52 offen offset:0 lds
    buffer_load_dwordx4 v125, s[24:27], s52 offen offset:1024 lds
    buffer_load_dwordx4 v126, s[24:27], s53 offen offset:2048 lds
    buffer_load_dwordx4 v126, s[24:27], s53 offen offset:3072 lds
    s_xor_b32 s39, s66, 3
    s_lshl_b32 s51, s39, 7
    s_add_u32 s51, s51, s36
    s_add_u32 m0, s38, 98304
    s_mul_i32 s52, s39, 196608
    buffer_load_dwordx4 v4, s[20:23], s51 offen offset:0 lds
    buffer_load_dwordx4 v5, s[20:23], s51 offen offset:1024 lds
    buffer_load_dwordx4 v6, s[20:23], s51 offen offset:2048 lds
    buffer_load_dwordx4 v7, s[20:23], s51 offen offset:3072 lds
    s_waitcnt vmcnt(12)
    s_waitcnt lgkmcnt(0)
    s_barrier
    ds_read_b128 v[144:147], v16 offset:32768
    ds_read_b128 v[148:151], v17 offset:32768
    ds_read_b128 v[152:155], v18 offset:32768
    ds_read_b128 v[156:159], v19 offset:32768
    v_xor_b32 v24, v12, v24
    v_xor_b32 v25, v12, v25
    v_xor_b32 v26, v12, v26
    v_xor_b32 v27, v12, v27
    v_xor_b32 v28, v12, v28
    v_xor_b32 v29, v12, v29
    v_xor_b32 v30, v12, v30
    v_xor_b32 v31, v12, v31
    v_xor_b32 v32, v12, v32
    v_xor_b32 v33, v12, v33
    v_xor_b32 v34, v12, v34
    v_xor_b32 v35, v12, v35
    v_xor_b32 v36, v12, v36
    v_xor_b32 v37, v12, v37
    v_xor_b32 v38, v12, v38
    v_xor_b32 v39, v12, v39
    s_add_u32 s52, s52, s37
    s_add_u32 m0, s38, 102400
    s_add_u32 s53, s52, 22528
    buffer_load_dwordx4 v125, s[24:27], s52 offen offset:0 lds
    buffer_load_dwordx4 v125, s[24:27], s52 offen offset:1024 lds
    buffer_load_dwordx4 v126, s[24:27], s53 offen offset:2048 lds
    buffer_load_dwordx4 v126, s[24:27], s53 offen offset:3072 lds
    s_xor_b32 s39, s66, 4
    s_lshl_b32 s51, s39, 7
    s_add_u32 s51, s51, s36
    s_add_u32 m0, s38, 131072
    s_mul_i32 s52, s39, 196608
    buffer_load_dwordx4 v4, s[20:23], s51 offen offset:0 lds
    buffer_load_dwordx4 v5, s[20:23], s51 offen offset:1024 lds
    buffer_load_dwordx4 v6, s[20:23], s51 offen offset:2048 lds
    buffer_load_dwordx4 v7, s[20:23], s51 offen offset:3072 lds
    s_waitcnt vmcnt(12)
    s_barrier
    ds_read_b128 v[160:163], v20 offset:0
    ds_read_b128 v[164:167], v21 offset:0
    ds_read_b128 v[168:171], v22 offset:0
    ds_read_b128 v[172:175], v23 offset:0
    s_cmp_lg_u32 s10, 0
    s_cbranch_scc1 K_h1
    buffer_load_dword v112, v15, s[60:63], 0 offen sc1
K_h1:
    s_add_u32 s52, s52, s37
    s_add_u32 m0, s38, 135168
    s_add_u32 s53, s52, 22528
    buffer_load_dwordx4 v125, s[24:27], s52 offen offset:0 lds
    buffer_load_dwordx4 v125, s[24:27], s52 offen offset:1024 lds
    buffer_load_dwordx4 v126, s[24:27], s53 offen offset:2048 lds
    buffer_load_dwordx4 v126, s[24:27], s53 offen offset:3072 lds
    s_waitcnt lgkmcnt(0)
    s_xor_b32 s39, s66, 5
    s_lshl_b32 s51, s39, 7
    s_add_u32 s51, s51, s36
    s_add_u32 m0, s38, 0
    s_mul_i32 s52, s39, 196608
    buffer_load_dwordx4 v4, s[20:23], s51 offen offset:0 lds
    buffer_load_dwordx4 v5, s[20:23], s51 offen offset:1024 lds
    buffer_load_dwordx4 v6, s[20:23], s51 offen offset:2048 lds
    buffer_load_dwordx4 v7, s[20:23], s51 offen offset:3072 lds
    s_waitcnt vmcnt(12)
    s_barrier
    ds_read_b128 v[176:179], v20 offset:32768
    ds_read_b128 v[180:183], v21 offset:32768
    ds_read_b128 v[184:187], v22 offset:32768
    ds_read_b128 v[188:191], v23 offset:32768
    s_add_u32 s52, s52, s37
    s_add_u32 m0, s38, 4096
    s_add_u32 s53, s52, 22528
    buffer_load_dwordx4 v125, s[24:27], s52 offen offset:0 lds
    buffer_load_dwordx4 v125, s[24:27], s52 offen offset:1024 lds
    buffer_load_dwordx4 v126, s[24:27], s53 offen offset:2048 lds
    buffer_load_dwordx4 v126, s[24:27], s53 offen offset:3072 lds
    s_waitcnt lgkmcnt(0)
    s_xor_b32 s39, s66, 6
    s_lshl_b32 s51, s39, 7
    s_add_u32 s51, s51, s36
    s_add_u32 m0, s38, 32768
    s_mul_i32 s52, s39, 196608
    buffer_load_dwordx4 v4, s[20:23], s51 offen offset:0 lds
    buffer_load_dwordx4 v5, s[20:23], s51 offen offset:1024 lds
    buffer_load_dwordx4 v6, s[20:23], s51 offen offset:2048 lds
    buffer_load_dwordx4 v7, s[20:23], s51 offen offset:3072 lds
    s_waitcnt vmcnt(12)
    s_barrier
    ds_read_b128 v[192:195], v118 offset:0
    ds_read_b128 v[196:199], v119 offset:0
    ds_read_b128 v[200:203], v120 offset:0
    ds_read_b128 v[204:207], v121 offset:0
    s_add_u32 s52, s52, s37
    s_add_u32 m0, s38, 36864
    s_add_u32 s53, s52, 22528
    buffer_load_dwordx4 v125, s[24:27], s52 offen offset:0 lds
    buffer_load_dwordx4 v125, s[24:27], s52 offen offset:1024 lds
    buffer_load_dwordx4 v126, s[24:27], s53 offen offset:2048 lds
    buffer_load_dwordx4 v126, s[24:27], s53 offen offset:3072 lds
    s_waitcnt lgkmcnt(0)
    s_xor_b32 s39, s66, 7
    s_lshl_b32 s51, s39, 7
    s_add_u32 s51, s51, s36
    s_add_u32 m0, s38, 65536
    s_mul_i32 s52, s39, 196608
    buffer_load_dwordx4 v4, s[20:23], s51 offen offset:0 lds
    buffer_load_dwordx4 v5, s[20:23], s51 offen offset:1024 lds
    buffer_load_dwordx4 v6, s[20:23], s51 offen offset:2048 lds
    buffer_load_dwordx4 v7, s[20:23], s51 offen offset:3072 lds
    s_waitcnt vmcnt(12)
    s_barrier
    ds_read_b128 v[208:211], v16 offset:0
    ds_read_b128 v[212:215], v17 offset:0
    ds_read_b128 v[216:219], v18 offset:0
    ds_read_b128 v[220:223], v19 offset:0
    s_cmp_lg_u32 s10, 0
    s_cbranch_scc1 K_h2
    s_mov_b32 s59, 0
K_h2l:
    v_readfirstlane_b32 s48, v112
    s_nop 0
    s_cmp_lg_u32 s48, 0
    s_cbranch_scc1 K_h2ok
    buffer_load_dword v112, v15, s[60:63], 0 offen sc1
    s_add_u32 s59, s59, 1
    s_waitcnt vmcnt(0)
    s_cmp_lt_u32 s59, 16384
    s_cbranch_scc1 K_h2l
K_h2ok:
    v_xor_b32 v122, s11, v112
    s_mov_b64 exec, 1
    buffer_store_dword v122, v15, s[28:31], s69 offen sc1
    s_mov_b64 exec, -1
K_h2:
    s_add_u32 s52, s52, s37
    s_add_u32 m0, s38, 69632
    s_add_u32 s53, s52, 22528
    buffer_load_dwordx4 v125, s[24:27], s52 offen offset:0 lds
    buffer_load_dwordx4 v125, s[24:27], s52 offen offset:1024 lds
    buffer_load_dwordx4 v126, s[24:27], s53 offen offset:2048 lds
    buffer_load_dwordx4 v126, s[24:27], s53 offen offset:3072 lds
    s_waitcnt vmcnt(8)
    s_waitcnt lgkmcnt(0)
    s_barrier
    ds_read_b128 v[224:227], v16 offset:32768
    ds_read_b128 v[228:231], v17 offset:32768
    ds_read_b128 v[232:235], v18 offset:32768
    ds_read_b128 v[236:239], v19 offset:32768
    s_cmp_lg_u32 s10, 0
    s_cbranch_scc1 K_h3
    ds_write_b32 v114, v112
K_h3:
    s_add_u32 s8, s64, 0
    s_and_b32 s8, s8, 63
    s_lshl_b32 s57, s8, 10
    s_add_u32 m0, s57, 98304
    s_xor_b32 s8, s8, s68
    s_mul_i32 s8, s8, 24576
    s_add_u32 s8, s8, s46
    buffer_load_dwordx4 v8, s[24:27], s8 offen lds
    s_add_u32 s8, s64, 4
    s_and_b32 s8, s8, 63
    s_lshl_b32 s57, s8, 10
    s_add_u32 m0, s57, 98304
    s_xor_b32 s8, s8, s68
    s_mul_i32 s8, s8, 24576
    s_add_u32 s8, s8, s46
    buffer_load_dwordx4 v8, s[24:27], s8 offen lds
    s_add_u32 s8, s64, 8
    s_and_b32 s8, s8, 63
    s_lshl_b32 s57, s8, 10
    s_add_u32 m0, s57, 98304
    s_xor_b32 s8, s8, s68
    s_mul_i32 s8, s8, 24576
    s_add_u32 s8, s8, s46
    buffer_load_dwordx4 v8, s[24:27], s8 offen lds
    s_add_u32 s8, s64, 12
    s_and_b32 s8, s8, 63
    s_lshl_b32 s57, s8, 10
    s_add_u32 m0, s57, 98304
    s_xor_b32 s8, s8, s68
    s_mul_i32 s8, s8, 24576
    s_add_u32 s8, s8, s46
    buffer_load_dwordx4 v8, s[24:27], s8 offen lds
    s_add_u32 s8, s64, 16
    s_and_b32 s8, s8, 63
    s_lshl_b32 s57, s8, 10
    s_add_u32 m0, s57, 98304
    s_xor_b32 s8, s8, s68
    s_mul_i32 s8, s8, 24576
    s_add_u32 s8, s8, s46
    buffer_load_dwordx4 v8, s[24:27], s8 offen lds
    s_add_u32 s8, s64, 20
    s_and_b32 s8, s8, 63
    s_lshl_b32 s57, s8, 10
    s_add_u32 m0, s57, 98304
    s_xor_b32 s8, s8, s68
    s_mul_i32 s8, s8, 24576
    s_add_u32 s8, s8, s46
    buffer_load_dwordx4 v8, s[24:27], s8 offen lds
    s_add_u32 s8, s64, 24
    s_and_b32 s8, s8, 63
    s_lshl_b32 s57, s8, 10
    s_add_u32 m0, s57, 98304
    s_xor_b32 s8, s8, s68
    s_mul_i32 s8, s8, 24576
    s_add_u32 s8, s8, s46
    buffer_load_dwordx4 v8, s[24:27], s8 offen lds
    s_add_u32 s8, s64, 28
    s_and_b32 s8, s8, 63
    s_lshl_b32 s57, s8, 10
    s_add_u32 m0, s57, 98304
    s_xor_b32 s8, s8, s68
    s_mul_i32 s8, s8, 24576
    s_add_u32 s8, s8, s46
    buffer_load_dwordx4 v8, s[24:27], s8 offen lds
    s_waitcnt vmcnt(8)
    s_waitcnt lgkmcnt(0)
    s_barrier
    ds_read_b128 v[240:243], v20 offset:0
    ds_read_b128 v[244:247], v21 offset:0
    ds_read_b128 v[248:251], v22 offset:0
    ds_read_b128 v[252:255], v23 offset:0
    buffer_store_dwordx2 v[106:107], v104, s[28:31], s12 offen offset:0 sc1
    buffer_store_dwordx2 v[106:107], v104, s[28:31], s12 offen offset:2048 sc1
    buffer_store_dwordx2 v[106:107], v104, s[28:31], s13 offen offset:0 sc1
    buffer_store_dwordx2 v[106:107], v104, s[28:31], s13 offen offset:2048 sc1
    buffer_store_dwordx2 v[106:107], v105, s[28:31], s14 offen sc1
    s_add_u32 s8, s64, 32
    s_and_b32 s8, s8, 63
    s_lshl_b32 s57, s8, 10
    s_add_u32 m0, s57, 98304
    s_xor_b32 s8, s8, s68
    s_mul_i32 s8, s8, 24576
    s_add_u32 s8, s8, s46
    buffer_load_dwordx4 v8, s[24:27], s8 offen lds
    s_add_u32 s8, s64, 36
    s_and_b32 s8, s8, 63
    s_lshl_b32 s57, s8, 10
    s_add_u32 m0, s57, 98304
    s_xor_b32 s8, s8, s68
    s_mul_i32 s8, s8, 24576
    s_add_u32 s8, s8, s46
    buffer_load_dwordx4 v8, s[24:27], s8 offen lds
    s_add_u32 s8, s64, 40
    s_and_b32 s8, s8, 63
    s_lshl_b32 s57, s8, 10
    s_add_u32 m0, s57, 98304
    s_xor_b32 s8, s8, s68
    s_mul_i32 s8, s8, 24576
    s_add_u32 s8, s8, s46
    buffer_load_dwordx4 v8, s[24:27], s8 offen lds
    s_add_u32 s8, s64, 44
    s_and_b32 s8, s8, 63
    s_lshl_b32 s57, s8, 10
    s_add_u32 m0, s57, 98304
    s_xor_b32 s8, s8, s68
    s_mul_i32 s8, s8, 24576
    s_add_u32 s8, s8, s46
    buffer_load_dwordx4 v8, s[24:27], s8 offen lds
    s_add_u32 s8, s64, 48
    s_and_b32 s8, s8, 63
    s_lshl_b32 s57, s8, 10
    s_add_u32 m0, s57, 98304
    s_xor_b32 s8, s8, s68
    s_mul_i32 s8, s8, 24576
    s_add_u32 s8, s8, s46
    buffer_load_dwordx4 v8, s[24:27], s8 offen lds
    s_add_u32 s8, s64, 52
    s_and_b32 s8, s8, 63
    s_lshl_b32 s57, s8, 10
    s_add_u32 m0, s57, 98304
    s_xor_b32 s8, s8, s68
    s_mul_i32 s8, s8, 24576
    s_add_u32 s8, s8, s46
    buffer_load_dwordx4 v8, s[24:27], s8 offen lds
    s_add_u32 s8, s64, 56
    s_and_b32 s8, s8, 63
    s_lshl_b32 s57, s8, 10
    s_add_u32 m0, s57, 98304
    s_xor_b32 s8, s8, s68
    s_mul_i32 s8, s8, 24576
    s_add_u32 s8, s8, s46
    buffer_load_dwordx4 v8, s[24:27], s8 offen lds
    s_add_u32 s8, s64, 60
    s_and_b32 s8, s8, 63
    s_lshl_b32 s57, s8, 10
    s_add_u32 m0, s57, 98304
    s_xor_b32 s8, s8, s68
    s_mul_i32 s8, s8, 24576
    s_add_u32 s8, s8, s46
    buffer_load_dwordx4 v8, s[24:27], s8 offen lds
    s_setprio 0
    s_lshl_b32 s39, s7, 3
    s_mov_b32 s32, s18
    s_mov_b32 s33, s19
    s_mov_b32 s34, 0x80000
    s_mov_b32 s35, 0x20000
    buffer_load_dword v124, v123, s[28:31], s47 offen sc1
    v_lshlrev_b32 v10, 10, v3
    s_lshl_b32 s8, s67, 16
    s_lshl_b32 s57, s10, 15
    s_add_u32 s8, s8, s57
    s_add_u32 s8, s8, s46
    buffer_load_dword v127, v15, s[28:31], s58 offen
    buffer_load_dword v127, v10, s[32:35], s8 offen
    s_waitcnt vmcnt(2) lgkmcnt(0)
    s_barrier
    ds_read_b32 v112, v114
    ds_read_b64_tr_b16 v[72:73], v115 offset:0
    ds_read_b64_tr_b16 v[74:75], v115 offset:512
    ds_read_b64_tr_b16 v[76:77], v115 offset:2048
    ds_read_b64_tr_b16 v[78:79], v115 offset:2560
    ds_read_b64_tr_b16 v[80:81], v115 offset:4096
    ds_read_b64_tr_b16 v[82:83], v115 offset:4608
    ds_read_b64_tr_b16 v[84:85], v115 offset:6144
    ds_read_b64_tr_b16 v[86:87], v115 offset:6656
    ds_read_b64_tr_b16 v[88:89], v115 offset:8192
    ds_read_b64_tr_b16 v[90:91], v115 offset:8704
    ds_read_b64_tr_b16 v[92:93], v115 offset:10240
    ds_read_b64_tr_b16 v[94:95], v115 offset:10752
    s_waitcnt lgkmcnt(10)
    v_mfma_f32_32x32x16_bf16 v[40:55], v[72:75], v[128:131], 0
    ds_read_b64_tr_b16 v[96:97], v115 offset:12288
    ds_read_b64_tr_b16 v[98:99], v115 offset:12800
    s_waitcnt lgkmcnt(10)
    v_mfma_f32_32x32x16_bf16 v[40:55], v[76:79], v[132:135], v[40:55]
    ds_read_b64_tr_b16 v[100:101], v115 offset:14336
    ds_read_b64_tr_b16 v[102:103], v115 offset:14848
    s_waitcnt lgkmcnt(10)
    v_mfma_f32_32x32x16_bf16 v[40:55], v[80:83], v[136:139], v[40:55]
    ds_read_b64_tr_b16 v[72:73], v115 offset:16384
    ds_read_b64_tr_b16 v[74:75], v115 offset:16896
    s_waitcnt lgkmcnt(10)
    v_mfma_f32_32x32x16_bf16 v[40:55], v[84:87], v[140:143], v[40:55]
    ds_read_b64_tr_b16 v[76:77], v115 offset:18432
    ds_read_b64_tr_b16 v[78:79], v115 offset:18944
    s_waitcnt lgkmcnt(10)
    v_mfma_f32_32x32x16_bf16 v[40:55], v[88:91], v[144:147], v[40:55]
    ds_read_b64_tr_b16 v[80:81], v115 offset:20480
    ds_read_b64_tr_b16 v[82:83], v115 offset:20992
    s_waitcnt lgkmcnt(10)
    v_mfma_f32_32x32x16_bf16 v[40:55], v[92:95], v[148:151], v[40:55]
    ds_read_b64_tr_b16 v[84:85], v115 offset:22528
    ds_read_b64_tr_b16 v[86:87], v115 offset:23040
    s_waitcnt lgkmcnt(10)
    v_mfma_f32_32x32x16_bf16 v[40:55], v[96:99], v[152:155], v[40:55]
    ds_read_b64_tr_b16 v[88:89], v115 offset:24576
    ds_read_b64_tr_b16 v[90:91], v115 offset:25088
    s_waitcnt lgkmcnt(10)
    v_mfma_f32_32x32x16_bf16 v[40:55], v[100:103], v[156:159], v[40:55]
    ds_read_b64_tr_b16 v[92:93], v115 offset:26624
    ds_read_b64_tr_b16 v[94:95], v115 offset:27136
    s_waitcnt lgkmcnt(10)
    v_mfma_f32_32x32x16_bf16 v[40:55], v[72:75], v[160:163], v[40:55]
    ds_read_b64_tr_b16 v[96:97], v115 offset:28672
    ds_read_b64_tr_b16 v[98:99], v115 offset:29184
    s_waitcnt lgkmcnt(10)
    v_mfma_f32_32x32x16_bf16 v[40:55], v[76:79], v[164:167], v[40:55]
    ds_read_b64_tr_b16 v[100:101], v115 offset:30720
    ds_read_b64_tr_b16 v[102:103], v115 offset:31232
    s_waitcnt lgkmcnt(10)
    v_mfma_f32_32x32x16_bf16 v[40:55], v[80:83], v[168:171], v[40:55]
    ds_read_b64_tr_b16 v[72:73], v115 offset:32768
    ds_read_b64_tr_b16 v[74:75], v115 offset:33280
    s_waitcnt lgkmcnt(10)
    v_mfma_f32_32x32x16_bf16 v[40:55], v[84:87], v[172:175], v[40:55]
    ds_read_b64_tr_b16 v[76:77], v115 offset:34816
    ds_read_b64_tr_b16 v[78:79], v115 offset:35328
    s_waitcnt lgkmcnt(10)
    v_mfma_f32_32x32x16_bf16 v[40:55], v[88:91], v[176:179], v[40:55]
    ds_read_b64_tr_b16 v[80:81], v115 offset:36864
    ds_read_b64_tr_b16 v[82:83], v115 offset:37376
    s_waitcnt lgkmcnt(10)
    v_mfma_f32_32x32x16_bf16 v[40:55], v[92:95], v[180:183], v[40:55]
    ds_read_b64_tr_b16 v[84:85], v115 offset:38912
    ds_read_b64_tr_b16 v[86:87], v115 offset:39424
    s_waitcnt lgkmcnt(10)
    v_mfma_f32_32x32x16_bf16 v[40:55], v[96:99], v[184:187], v[40:55]
    ds_read_b64_tr_b16 v[88:89], v115 offset:40960
    ds_read_b64_tr_b16 v[90:91], v115 offset:41472
    s_waitcnt lgkmcnt(10)
    v_mfma_f32_32x32x16_bf16 v[40:55], v[100:103], v[188:191], v[40:55]
    ds_read_b64_tr_b16 v[92:93], v115 offset:43008
    ds_read_b64_tr_b16 v[94:95], v115 offset:43520
    s_waitcnt lgkmcnt(10)
    v_mfma_f32_32x32x16_bf16 v[40:55], v[72:75], v[192:195], v[40:55]
    ds_read_b64_tr_b16 v[96:97], v115 offset:45056
    ds_read_b64_tr_b16 v[98:99], v115 offset:45568
    s_waitcnt lgkmcnt(10)
    v_mfma_f32_32x32x16_bf16 v[40:55], v[76:79], v[196:199], v[40:55]
    ds_read_b64_tr_b16 v[100:101], v115 offset:47104
    ds_read_b64_tr_b16 v[102:103], v115 offset:47616
    s_waitcnt lgkmcnt(10)
    v_mfma_f32_32x32x16_bf16 v[40:55], v[80:83], v[200:203], v[40:55]
    ds_read_b64_tr_b16 v[72:73], v115 offset:49152
    ds_read_b64_tr_b16 v[74:75], v115 offset:49664
    s_waitcnt lgkmcnt(10)
    v_mfma_f32_32x32x16_bf16 v[40:55], v[84:87], v[204:207], v[40:55]
    ds_read_b64_tr_b16 v[76:77], v115 offset:51200
    ds_read_b64_tr_b16 v[78:79], v115 offset:51712
    s_waitcnt lgkmcnt(10)
    v_mfma_f32_32x32x16_bf16 v[40:55], v[88:91], v[208:211], v[40:55]
    ds_read_b64_tr_b16 v[80:81], v115 offset:53248
    ds_read_b64_tr_b16 v[82:83], v115 offset:53760
    s_waitcnt lgkmcnt(10)
    v_mfma_f32_32x32x16_bf16 v[40:55], v[92:95], v[212:215], v[40:55]
    ds_read_b64_tr_b16 v[84:85], v115 offset:55296
    ds_read_b64_tr_b16 v[86:87], v115 offset:55808
    s_waitcnt lgkmcnt(10)
    v_mfma_f32_32x32x16_bf16 v[40:55], v[96:99], v[216:219], v[40:55]
    ds_read_b64_tr_b16 v[88:89], v115 offset:57344
    ds_read_b64_tr_b16 v[90:91], v115 offset:57856
    s_waitcnt lgkmcnt(10)
    v_mfma_f32_32x32x16_bf16 v[40:55], v[100:103], v[220:223], v[40:55]
    ds_read_b64_tr_b16 v[92:93], v115 offset:59392
    ds_read_b64_tr_b16 v[94:95], v115 offset:59904
    s_waitcnt lgkmcnt(10)
    v_mfma_f32_32x32x16_bf16 v[40:55], v[72:75], v[224:227], v[40:55]
    ds_read_b64_tr_b16 v[96:97], v115 offset:61440
    ds_read_b64_tr_b16 v[98:99], v115 offset:61952
    s_waitcnt lgkmcnt(10)
    v_mfma_f32_32x32x16_bf16 v[40:55], v[76:79], v[228:231], v[40:55]
    ds_read_b64_tr_b16 v[100:101], v115 offset:63488
    ds_read_b64_tr_b16 v[102:103], v115 offset:64000
    s_waitcnt lgkmcnt(10)
    v_mfma_f32_32x32x16_bf16 v[40:55], v[80:83], v[232:235], v[40:55]
    ds_read_b64_tr_b16 v[72:73], v116 offset:0
    ds_read_b64_tr_b16 v[74:75], v116 offset:512
    s_waitcnt lgkmcnt(10)
    v_mfma_f32_32x32x16_bf16 v[40:55], v[84:87], v[236:239], v[40:55]
    ds_read_b64_tr_b16 v[76:77], v116 offset:2048
    ds_read_b64_tr_b16 v[78:79], v116 offset:2560
    s_waitcnt lgkmcnt(10)
    v_mfma_f32_32x32x16_bf16 v[40:55], v[88:91], v[240:243], v[40:55]
    ds_read_b64_tr_b16 v[80:81], v116 offset:4096
    ds_read_b64_tr_b16 v[82:83], v116 offset:4608
    s_waitcnt lgkmcnt(10)
    v_mfma_f32_32x32x16_bf16 v[40:55], v[92:95], v[244:247], v[40:55]
    ds_read_b64_tr_b16 v[84:85], v116 offset:6144
    ds_read_b64_tr_b16 v[86:87], v116 offset:6656
    s_waitcnt lgkmcnt(10)
    v_mfma_f32_32x32x16_bf16 v[40:55], v[96:99], v[248:251], v[40:55]
    ds_read_b64_tr_b16 v[88:89], v116 offset:8192
    ds_read_b64_tr_b16 v[90:91], v116 offset:8704
    s_waitcnt lgkmcnt(10)
    v_mfma_f32_32x32x16_bf16 v[40:55], v[100:103], v[252:255], v[40:55]
    ds_read_b64_tr_b16 v[92:93], v116 offset:10240
    ds_read_b64_tr_b16 v[94:95], v116 offset:10752
    s_waitcnt lgkmcnt(10)
    v_mfma_f32_32x32x16_bf16 v[56:71], v[72:75], v[128:131], 0
    ds_read_b64_tr_b16 v[96:97], v116 offset:12288
    ds_read_b64_tr_b16 v[98:99], v116 offset:12800
    s_waitcnt lgkmcnt(10)
    v_mfma_f32_32x32x16_bf16 v[56:71], v[76:79], v[132:135], v[56:71]
    ds_read_b64_tr_b16 v[100:101], v116 offset:14336
    ds_read_b64_tr_b16 v[102:103], v116 offset:14848
    s_waitcnt lgkmcnt(10)
    v_mfma_f32_32x32x16_bf16 v[56:71], v[80:83], v[136:139], v[56:71]
    ds_read_b64_tr_b16 v[72:73], v116 offset:16384
    ds_read_b64_tr_b16 v[74:75], v116 offset:16896
    v_cvt_pk_bf16_f32 v4, v40, v41
    v_cvt_pk_bf16_f32 v5, v42, v43
    v_cvt_pk_bf16_f32 v6, v44, v45
    v_cvt_pk_bf16_f32 v7, v46, v47
    s_waitcnt lgkmcnt(10)
    v_mfma_f32_32x32x16_bf16 v[56:71], v[84:87], v[140:143], v[56:71]
    ds_read_b64_tr_b16 v[76:77], v116 offset:18432
    ds_read_b64_tr_b16 v[78:79], v116 offset:18944
    v_cvt_pk_bf16_f32 v118, v48, v49
    v_cvt_pk_bf16_f32 v119, v50, v51
    v_cvt_pk_bf16_f32 v120, v52, v53
    v_cvt_pk_bf16_f32 v121, v54, v55
    s_nop 1
    v_mfma_f32_32x32x16_bf16 v[40:55], v[28:31], v[118:121], 0
    s_waitcnt lgkmcnt(10)
    v_mfma_f32_32x32x16_bf16 v[56:71], v[88:91], v[144:147], v[56:71]
    ds_read_b64_tr_b16 v[80:81], v116 offset:20480
    ds_read_b64_tr_b16 v[82:83], v116 offset:20992
    v_mfma_f32_32x32x16_bf16 v[128:143], v[24:27], v[4:7], 0
    s_waitcnt lgkmcnt(10)
    v_mfma_f32_32x32x16_bf16 v[56:71], v[92:95], v[148:151], v[56:71]
    ds_read_b64_tr_b16 v[84:85], v116 offset:22528
    ds_read_b64_tr_b16 v[86:87], v116 offset:23040
    s_waitcnt lgkmcnt(10)
    v_mfma_f32_32x32x16_bf16 v[56:71], v[96:99], v[152:155], v[56:71]
    ds_read_b64_tr_b16 v[88:89], v116 offset:24576
    ds_read_b64_tr_b16 v[90:91], v116 offset:25088
    s_waitcnt lgkmcnt(10)
    v_mfma_f32_32x32x16_bf16 v[56:71], v[100:103], v[156:159], v[56:71]
    ds_read_b64_tr_b16 v[92:93], v116 offset:26624
    ds_read_b64_tr_b16 v[94:95], v116 offset:27136
    v_max3_f32 v12, v40, v41, v42
    v_max3_f32 v10, v128, v129, v130
    v_max3_f32 v13, v43, v44, v45
    v_max3_f32 v11, v131, v132, v133
    v_max3_f32 v12, v12, v46, v47
    v_max3_f32 v10, v10, v134, v135
    s_waitcnt lgkmcnt(10)
    v_mfma_f32_32x32x16_bf16 v[56:71], v[72:75], v[160:163], v[56:71]
    ds_read_b64_tr_b16 v[96:97], v116 offset:28672
    ds_read_b64_tr_b16 v[98:99], v116 offset:29184
    v_max3_f32 v13, v13, v48, v49
    v_max3_f32 v11, v11, v136, v137
    v_max3_f32 v12, v12, v50, v51
    v_max3_f32 v10, v10, v138, v139
    v_max3_f32 v13, v13, v52, v53
    v_max3_f32 v11, v11, v140, v141
    s_waitcnt lgkmcnt(10)
    v_mfma_f32_32x32x16_bf16 v[56:71], v[76:79], v[164:167], v[56:71]
    ds_read_b64_tr_b16 v[100:101], v116 offset:30720
    ds_read_b64_tr_b16 v[102:103], v116 offset:31232
    v_max3_f32 v12, v12, v54, v55
    v_max3_f32 v10, v10, v142, v143
    v_max_f32 v12, v12, v13
    v_max_f32 v10, v10, v11
    v_mul_f32 v12, s56, v12
    v_mul_f32 v10, s56, v10
    s_waitcnt lgkmcnt(10)
    v_mfma_f32_32x32x16_bf16 v[56:71], v[80:83], v[168:171], v[56:71]
    ds_read_b64_tr_b16 v[72:73], v116 offset:32768
    ds_read_b64_tr_b16 v[74:75], v116 offset:33280
    v_fma_f32 v40, v40, s54, v12
    v_fma_f32 v128, v128, s54, v10
    v_fma_f32 v41, v41, s54, v12
    v_fma_f32 v129, v129, s54, v10
    v_fma_f32 v42, v42, s54, v12
    v_fma_f32 v130, v130, s54, v10
    s_waitcnt lgkmcnt(10)
    v_mfma_f32_32x32x16_bf16 v[56:71], v[84:87], v[172:175], v[56:71]
    ds_read_b64_tr_b16 v[76:77], v116 offset:34816
    ds_read_b64_tr_b16 v[78:79], v116 offset:35328
    v_fma_f32 v43, v43, s54, v12
    v_fma_f32 v131, v131, s54, v10
    v_fma_f32 v44, v44, s54, v12
    v_fma_f32 v132, v132, s54, v10
    v_fma_f32 v45, v45, s54, v12
    v_fma_f32 v133, v133, s54, v10
    s_waitcnt lgkmcnt(10)
    v_mfma_f32_32x32x16_bf16 v[56:71], v[88:91], v[176:179], v[56:71]
    ds_read_b64_tr_b16 v[80:81], v116 offset:36864
    ds_read_b64_tr_b16 v[82:83], v116 offset:37376
    v_fma_f32 v46, v46, s54, v12
    v_fma_f32 v134, v134, s54, v10
    v_fma_f32 v47, v47, s54, v12
    v_fma_f32 v135, v135, s54, v10
    v_fma_f32 v48, v48, s54, v12
    v_fma_f32 v136, v136, s54, v10
    s_waitcnt lgkmcnt(10)
    v_mfma_f32_32x32x16_bf16 v[56:71], v[92:95], v[180:183], v[56:71]
    ds_read_b64_tr_b16 v[84:85], v116 offset:38912
    ds_read_b64_tr_b16 v[86:87], v116 offset:39424
    v_fma_f32 v49, v49, s54, v12
    v_fma_f32 v137, v137, s54, v10
    v_fma_f32 v50, v50, s54, v12
    v_fma_f32 v138, v138, s54, v10
    v_fma_f32 v51, v51, s54, v12
    v_fma_f32 v139, v139, s54, v10
    s_waitcnt lgkmcnt(10)
    v_mfma_f32_32x32x16_bf16 v[56:71], v[96:99], v[184:187], v[56:71]
    ds_read_b64_tr_b16 v[88:89], v116 offset:40960
    ds_read_b64_tr_b16 v[90:91], v116 offset:41472
    v_fma_f32 v52, v52, s54, v12
    v_fma_f32 v140, v140, s54, v10
    v_fma_f32 v53, v53, s54, v12
    v_fma_f32 v141, v141, s54, v10
    v_fma_f32 v54, v54, s54, v12
    v_fma_f32 v142, v142, s54, v10
    s_waitcnt lgkmcnt(10)
    v_mfma_f32_32x32x16_bf16 v[56:71], v[100:103], v[188:191], v[56:71]
    ds_read_b64_tr_b16 v[92:93], v116 offset:43008
    ds_read_b64_tr_b16 v[94:95], v116 offset:43520
    v_fma_f32 v55, v55, s54, v12
    v_fma_f32 v143, v143, s54, v10
    v_exp_f32 v40, v40
    v_exp_f32 v128, v128
    s_waitcnt lgkmcnt(10)
    v_mfma_f32_32x32x16_bf16 v[56:71], v[72:75], v[192:195], v[56:71]
    ds_read_b64_tr_b16 v[96:97], v116 offset:45056
    ds_read_b64_tr_b16 v[98:99], v116 offset:45568
    v_exp_f32 v41, v41
    v_exp_f32 v129, v129
    v_exp_f32 v42, v42
    s_waitcnt lgkmcnt(10)
    v_mfma_f32_32x32x16_bf16 v[56:71], v[76:79], v[196:199], v[56:71]
    ds_read_b64_tr_b16 v[100:101], v116 offset:47104
    ds_read_b64_tr_b16 v[102:103], v116 offset:47616
    v_exp_f32 v130, v130
    v_exp_f32 v43, v43
    v_exp_f32 v131, v131
    s_waitcnt lgkmcnt(10)
    v_mfma_f32_32x32x16_bf16 v[56:71], v[80:83], v[200:203], v[56:71]
    ds_read_b64_tr_b16 v[72:73], v116 offset:49152
    ds_read_b64_tr_b16 v[74:75], v116 offset:49664
    v_exp_f32 v44, v44
    v_exp_f32 v132, v132
    v_exp_f32 v45, v45
    s_waitcnt lgkmcnt(10)
    v_mfma_f32_32x32x16_bf16 v[56:71], v[84:87], v[204:207], v[56:71]
    ds_read_b64_tr_b16 v[76:77], v116 offset:51200
    ds_read_b64_tr_b16 v[78:79], v116 offset:51712
    v_exp_f32 v133, v133
    v_exp_f32 v46, v46
    v_exp_f32 v134, v134
    s_waitcnt lgkmcnt(10)
    v_mfma_f32_32x32x16_bf16 v[56:71], v[88:91], v[208:211], v[56:71]
    ds_read_b64_tr_b16 v[80:81], v116 offset:53248
    ds_read_b64_tr_b16 v[82:83], v116 offset:53760
    v_exp_f32 v47, v47
    v_exp_f32 v135, v135
    v_exp_f32 v48, v48
    s_waitcnt lgkmcnt(10)
    v_mfma_f32_32x32x16_bf16 v[56:71], v[92:95], v[212:215], v[56:71]
    ds_read_b64_tr_b16 v[84:85], v116 offset:55296
    ds_read_b64_tr_b16 v[86:87], v116 offset:55808
    v_exp_f32 v136, v136
    v_exp_f32 v49, v49
    v_exp_f32 v137, v137
    s_waitcnt lgkmcnt(10)
    v_mfma_f32_32x32x16_bf16 v[56:71], v[96:99], v[216:219], v[56:71]
    ds_read_b64_tr_b16 v[88:89], v116 offset:57344
    ds_read_b64_tr_b16 v[90:91], v116 offset:57856
    v_exp_f32 v50, v50
    v_exp_f32 v138, v138
    v_exp_f32 v51, v51
    s_waitcnt lgkmcnt(10)
    v_mfma_f32_32x32x16_bf16 v[56:71], v[100:103], v[220:223], v[56:71]
    ds_read_b64_tr_b16 v[92:93], v116 offset:59392
    ds_read_b64_tr_b16 v[94:95], v116 offset:59904
    v_exp_f32 v139, v139
    v_exp_f32 v52, v52
    v_exp_f32 v140, v140
    s_waitcnt lgkmcnt(10)
    v_mfma_f32_32x32x16_bf16 v[56:71], v[72:75], v[224:227], v[56:71]
    ds_read_b64_tr_b16 v[96:97], v116 offset:61440
    ds_read_b64_tr_b16 v[98:99], v116 offset:61952
    v_exp_f32 v53, v53
    v_exp_f32 v141, v141
    v_exp_f32 v54, v54
    s_waitcnt lgkmcnt(10)
    v_mfma_f32_32x32x16_bf16 v[56:71], v[76:79], v[228:231], v[56:71]
    ds_read_b64_tr_b16 v[100:101], v116 offset:63488
    ds_read_b64_tr_b16 v[102:103], v116 offset:64000
    v_exp_f32 v142, v142
    v_exp_f32 v55, v55
    v_exp_f32 v143, v143
    s_waitcnt lgkmcnt(10)
    v_mfma_f32_32x32x16_bf16 v[56:71], v[80:83], v[232:235], v[56:71]
    v_add_f32 v12, v40, v41
    v_add_f32 v10, v128, v129
    v_add_f32 v13, v42, v43
    v_add_f32 v11, v130, v131
    v_add_f32 v12, v12, v44
    v_add_f32 v10, v10, v132
    s_waitcnt lgkmcnt(8)
    v_mfma_f32_32x32x16_bf16 v[56:71], v[84:87], v[236:239], v[56:71]
    v_add_f32 v13, v13, v45
    v_add_f32 v11, v11, v133
    v_add_f32 v12, v12, v46
    v_add_f32 v10, v10, v134
    v_add_f32 v13, v13, v47
    v_add_f32 v11, v11, v135
    s_waitcnt lgkmcnt(6)
    v_mfma_f32_32x32x16_bf16 v[56:71], v[88:91], v[240:243], v[56:71]
    v_add_f32 v12, v12, v48
    v_add_f32 v10, v10, v136
    v_add_f32 v13, v13, v49
    v_add_f32 v11, v11, v137
    v_add_f32 v12, v12, v50
    v_add_f32 v10, v10, v138
    s_waitcnt lgkmcnt(4)
    v_mfma_f32_32x32x16_bf16 v[56:71], v[92:95], v[244:247], v[56:71]
    v_add_f32 v13, v13, v51
    v_add_f32 v11, v11, v139
    v_add_f32 v12, v12, v52
    v_add_f32 v10, v10, v140
    v_add_f32 v13, v13, v53
    v_add_f32 v11, v11, v141
    s_waitcnt lgkmcnt(2)
    v_mfma_f32_32x32x16_bf16 v[56:71], v[96:99], v[248:251], v[56:71]
    v_add_f32 v12, v12, v54
    v_add_f32 v10, v10, v142
    v_add_f32 v13, v13, v55
    v_add_f32 v11, v11, v143
    v_add_f32 v12, v12, v13
    v_add_f32 v10, v10, v11
    s_waitcnt lgkmcnt(0)
    v_mfma_f32_32x32x16_bf16 v[56:71], v[100:103], v[252:255], v[56:71]
    v_rcp_f32 v12, v12
    v_rcp_f32 v10, v10
    v_mul_f32 v40, v12, v40
    v_mul_f32 v128, v10, v128
    v_mul_f32 v41, v12, v41
    v_mul_f32 v129, v10, v129
    v_mul_f32 v42, v12, v42
    v_mul_f32 v130, v10, v130
    v_mul_f32 v43, v12, v43
    v_mul_f32 v131, v10, v131
    v_mul_f32 v44, v12, v44
    v_mul_f32 v132, v10, v132
    v_mul_f32 v45, v12, v45
    v_mul_f32 v133, v10, v133
    v_mul_f32 v46, v12, v46
    v_mul_f32 v134, v10, v134
    v_mul_f32 v47, v12, v47
    v_mul_f32 v135, v10, v135
    v_cvt_pk_bf16_f32 v72, v56, v57
    v_cvt_pk_bf16_f32 v73, v58, v59
    v_cvt_pk_bf16_f32 v74, v60, v61
    v_cvt_pk_bf16_f32 v75, v62, v63
    s_nop 1
    v_mfma_f32_32x32x16_bf16 v[160:175], v[32:35], v[72:75], 0
    v_cvt_pk_bf16_f32 v76, v64, v65
    v_cvt_pk_bf16_f32 v77, v66, v67
    v_cvt_pk_bf16_f32 v78, v68, v69
    v_cvt_pk_bf16_f32 v79, v70, v71
    s_nop 1
    v_mfma_f32_32x32x16_bf16 v[176:191], v[36:39], v[76:79], 0
    v_mul_f32 v48, v12, v48
    v_mul_f32 v136, v10, v136
    v_mul_f32 v49, v12, v49
    v_mul_f32 v137, v10, v137
    v_mul_f32 v50, v12, v50
    v_mul_f32 v138, v10, v138
    v_mul_f32 v51, v12, v51
    v_mul_f32 v139, v10, v139
    v_mul_f32 v52, v12, v52
    v_mul_f32 v140, v10, v140
    v_mul_f32 v53, v12, v53
    v_mul_f32 v141, v10, v141
    v_mul_f32 v54, v12, v54
    v_mul_f32 v142, v10, v142
    v_mul_f32 v55, v12, v55
    v_mul_f32 v143, v10, v143
    v_cvt_pk_bf16_f32 v104, v40, v41
    v_cvt_pk_bf16_f32 v16, v128, v129
    v_cvt_pk_bf16_f32 v105, v42, v43
    v_cvt_pk_bf16_f32 v17, v130, v131
    v_cvt_pk_bf16_f32 v106, v44, v45
    v_cvt_pk_bf16_f32 v18, v132, v133
    v_cvt_pk_bf16_f32 v107, v46, v47
    v_cvt_pk_bf16_f32 v19, v134, v135
    v_cvt_pk_bf16_f32 v108, v48, v49
    v_cvt_pk_bf16_f32 v20, v136, v137
    v_cvt_pk_bf16_f32 v109, v50, v51
    v_cvt_pk_bf16_f32 v21, v138, v139
    v_cvt_pk_bf16_f32 v110, v52, v53
    v_cvt_pk_bf16_f32 v22, v140, v141
    v_cvt_pk_bf16_f32 v111, v54, v55
    v_cvt_pk_bf16_f32 v23, v142, v143
    v_xor_b32 v122, s11, v112
    v_cmp_ne_u32 vcc, v122, v124
    v_max3_f32 v80, v160, v161, v162
    v_max3_f32 v84, v176, v177, v178
    v_max3_f32 v81, v163, v164, v165
    v_max3_f32 v85, v179, v180, v181
    v_max3_f32 v80, v80, v166, v167
    v_max3_f32 v84, v84, v182, v183
    v_max3_f32 v81, v81, v168, v169
    v_max3_f32 v85, v85, v184, v185
    v_max3_f32 v80, v80, v170, v171
    v_max3_f32 v84, v84, v186, v187
    v_max3_f32 v81, v81, v172, v173
    v_max3_f32 v85, v85, v188, v189
    v_max3_f32 v80, v80, v174, v175
    v_max3_f32 v84, v84, v190, v191
    v_max_f32 v80, v80, v81
    v_max_f32 v84, v84, v85
    v_mul_f32 v80, s56, v80
    v_mul_f32 v84, s56, v84
    v_pk_fma_f32 v[160:161], v[160:161], s[54:55], v[80:81] op_sel_hi:[1,1,0]
    v_pk_fma_f32 v[176:177], v[176:177], s[54:55], v[84:85] op_sel_hi:[1,1,0]
    v_pk_fma_f32 v[162:163], v[162:163], s[54:55], v[80:81] op_sel_hi:[1,1,0]
    v_pk_fma_f32 v[178:179], v[178:179], s[54:55], v[84:85] op_sel_hi:[1,1,0]
    v_pk_fma_f32 v[164:165], v[164:165], s[54:55], v[80:81] op_sel_hi:[1,1,0]
    v_pk_fma_f32 v[180:181], v[180:181], s[54:55], v[84:85] op_sel_hi:[1,1,0]
    v_pk_fma_f32 v[166:167], v[166:167], s[54:55], v[80:81] op_sel_hi:[1,1,0]
    v_pk_fma_f32 v[182:183], v[182:183], s[54:55], v[84:85] op_sel_hi:[1,1,0]
    v_pk_fma_f32 v[168:169], v[168:169], s[54:55], v[80:81] op_sel_hi:[1,1,0]
    v_pk_fma_f32 v[184:185], v[184:185], s[54:55], v[84:85] op_sel_hi:[1,1,0]
    v_pk_fma_f32 v[170:171], v[170:171], s[54:55], v[80:81] op_sel_hi:[1,1,0]
    v_pk_fma_f32 v[186:187], v[186:187], s[54:55], v[84:85] op_sel_hi:[1,1,0]
    v_pk_fma_f32 v[172:173], v[172:173], s[54:55], v[80:81] op_sel_hi:[1,1,0]
    v_pk_fma_f32 v[188:189], v[188:189], s[54:55], v[84:85] op_sel_hi:[1,1,0]
    v_pk_fma_f32 v[174:175], v[174:175], s[54:55], v[80:81] op_sel_hi:[1,1,0]
    v_pk_fma_f32 v[190:191], v[190:191], s[54:55], v[84:85] op_sel_hi:[1,1,0]
    v_exp_f32 v160, v160
    v_exp_f32 v176, v176
    v_exp_f32 v161, v161
    v_exp_f32 v177, v177
    v_exp_f32 v162, v162
    v_exp_f32 v178, v178
    v_exp_f32 v163, v163
    v_exp_f32 v179, v179
    v_exp_f32 v164, v164
    v_exp_f32 v180, v180
    v_exp_f32 v165, v165
    v_exp_f32 v181, v181
    v_exp_f32 v166, v166
    v_exp_f32 v182, v182
    v_exp_f32 v167, v167
    v_exp_f32 v183, v183
    v_exp_f32 v168, v168
    v_exp_f32 v184, v184
    v_exp_f32 v169, v169
    v_exp_f32 v185, v185
    v_exp_f32 v170, v170
    v_exp_f32 v186, v186
    v_exp_f32 v171, v171
    v_exp_f32 v187, v187
    v_exp_f32 v172, v172
    v_exp_f32 v188, v188
    v_exp_f32 v173, v173
    v_exp_f32 v189, v189
    v_exp_f32 v174, v174
    v_exp_f32 v190, v190
    v_exp_f32 v175, v175
    v_exp_f32 v191, v191
    v_pk_add_f32 v[80:81], v[160:161], v[162:163]
    v_pk_add_f32 v[84:85], v[176:177], v[178:179]
    v_pk_add_f32 v[82:83], v[164:165], v[166:167]
    v_pk_add_f32 v[86:87], v[180:181], v[182:183]
    v_pk_add_f32 v[80:81], v[80:81], v[168:169]
    v_pk_add_f32 v[84:85], v[84:85], v[184:185]
    v_pk_add_f32 v[82:83], v[82:83], v[170:171]
    v_pk_add_f32 v[86:87], v[86:87], v[186:187]
    v_pk_add_f32 v[80:81], v[80:81], v[172:173]
    v_pk_add_f32 v[84:85], v[84:85], v[188:189]
    v_pk_add_f32 v[82:83], v[82:83], v[174:175]
    v_pk_add_f32 v[86:87], v[86:87], v[190:191]
    v_pk_add_f32 v[80:81], v[80:81], v[82:83]
    v_pk_add_f32 v[84:85], v[84:85], v[86:87]
    v_add_f32 v80, v80, v81
    v_add_f32 v84, v84, v85
    v_rcp_f32 v80, v80
    v_rcp_f32 v84, v84
    v_pk_mul_f32 v[160:161], v[160:161], v[80:81] op_sel_hi:[1,0]
    v_pk_mul_f32 v[176:177], v[176:177], v[84:85] op_sel_hi:[1,0]
    v_pk_mul_f32 v[162:163], v[162:163], v[80:81] op_sel_hi:[1,0]
    v_pk_mul_f32 v[178:179], v[178:179], v[84:85] op_sel_hi:[1,0]
    v_pk_mul_f32 v[164:165], v[164:165], v[80:81] op_sel_hi:[1,0]
    v_pk_mul_f32 v[180:181], v[180:181], v[84:85] op_sel_hi:[1,0]
    v_pk_mul_f32 v[166:167], v[166:167], v[80:81] op_sel_hi:[1,0]
    v_pk_mul_f32 v[182:183], v[182:183], v[84:85] op_sel_hi:[1,0]
    v_pk_mul_f32 v[168:169], v[168:169], v[80:81] op_sel_hi:[1,0]
    v_pk_mul_f32 v[184:185], v[184:185], v[84:85] op_sel_hi:[1,0]
    v_pk_mul_f32 v[170:171], v[170:171], v[80:81] op_sel_hi:[1,0]
    v_pk_mul_f32 v[186:187], v[186:187], v[84:85] op_sel_hi:[1,0]
    v_pk_mul_f32 v[172:173], v[172:173], v[80:81] op_sel_hi:[1,0]
    v_pk_mul_f32 v[188:189], v[188:189], v[84:85] op_sel_hi:[1,0]
    v_pk_mul_f32 v[174:175], v[174:175], v[80:81] op_sel_hi:[1,0]
    v_pk_mul_f32 v[190:191], v[190:191], v[84:85] op_sel_hi:[1,0]
    v_cvt_pk_bf16_f32 v208, v160, v161
    v_cvt_pk_bf16_f32 v216, v176, v177
    v_cvt_pk_bf16_f32 v209, v162, v163
    v_cvt_pk_bf16_f32 v217, v178, v179
    v_cvt_pk_bf16_f32 v210, v164, v165
    v_cvt_pk_bf16_f32 v218, v180, v181
    v_cvt_pk_bf16_f32 v211, v166, v167
    v_cvt_pk_bf16_f32 v219, v182, v183
    v_cvt_pk_bf16_f32 v212, v168, v169
    v_cvt_pk_bf16_f32 v220, v184, v185
    v_cvt_pk_bf16_f32 v213, v170, v171
    v_cvt_pk_bf16_f32 v221, v186, v187
    v_cvt_pk_bf16_f32 v214, v172, v173
    v_cvt_pk_bf16_f32 v222, v188, v189
    v_cvt_pk_bf16_f32 v215, v174, v175
    v_cvt_pk_bf16_f32 v223, v190, v191
    s_and_b32 s59, vcc_lo, 0xff
    v_add_u32 v126, s38, v14
    s_setprio 3
    s_waitcnt vmcnt(0)
    s_barrier
    s_cmp_eq_u32 s59, 0
    ds_read_b128 v[40:43], v117 offset:0
    ds_read_b128 v[44:47], v117 offset:1024
    ds_read_b128 v[48:51], v117 offset:8192
    ds_read_b128 v[52:55], v117 offset:9216
    ds_read_b128 v[56:59], v117 offset:16384
    ds_read_b128 v[60:63], v117 offset:17408
    ds_read_b128 v[64:67], v117 offset:24576
    ds_read_b128 v[68:71], v117 offset:25600
    s_waitcnt lgkmcnt(6)
    v_mfma_f32_32x32x16_bf16 v[128:143], v[40:43], v[16:19], 0
    v_mfma_f32_32x32x16_bf16 v[128:143], v[44:47], v[20:23], v[128:143]
    s_waitcnt lgkmcnt(4)
    v_mfma_f32_32x32x16_bf16 v[144:159], v[48:51], v[104:107], 0
    v_mfma_f32_32x32x16_bf16 v[144:159], v[52:55], v[108:111], v[144:159]
    s_waitcnt lgkmcnt(2)
    v_mfma_f32_32x32x16_bf16 v[160:175], v[56:59], v[208:211], 0
    v_mfma_f32_32x32x16_bf16 v[160:175], v[60:63], v[212:215], v[160:175]
    s_nop 5
    v_add_f32 v136, 0x358637bd, v136
    v_rcp_f32 v136, v136
    s_nop 0
    v_mul_f32 v128, v136, v128
    v_mul_f32 v129, v136, v129
    v_mul_f32 v130, v136, v130
    v_mul_f32 v131, v136, v131
    s_waitcnt lgkmcnt(0)
    v_mfma_f32_32x32x16_bf16 v[176:191], v[64:67], v[216:219], 0
    v_mfma_f32_32x32x16_bf16 v[176:191], v[68:71], v[220:223], v[176:191]
    v_mul_f32 v132, v136, v132
    v_mul_f32 v133, v136, v133
    v_mul_f32 v134, v136, v134
    v_mul_f32 v135, v136, v135
    v_cvt_pk_bf16_f32 v140, v128, v129
    v_cvt_pk_bf16_f32 v141, v130, v131
    v_cvt_pk_bf16_f32 v142, v132, v133
    v_cvt_pk_bf16_f32 v143, v134, v135
    buffer_store_dwordx4 v[140:143], v14, s[28:31], s50 offen offset:0 sc1
    v_add_f32 v152, 0x358637bd, v152
    v_rcp_f32 v152, v152
    s_nop 0
    v_mul_f32 v144, v152, v144
    v_mul_f32 v145, v152, v145
    v_mul_f32 v146, v152, v146
    v_mul_f32 v147, v152, v147
    v_mul_f32 v148, v152, v148
    v_mul_f32 v149, v152, v149
    v_mul_f32 v150, v152, v150
    v_mul_f32 v151, v152, v151
    v_cvt_pk_bf16_f32 v156, v144, v145
    v_cvt_pk_bf16_f32 v157, v146, v147
    v_cvt_pk_bf16_f32 v158, v148, v149
    v_cvt_pk_bf16_f32 v159, v150, v151
    buffer_store_dwordx4 v[156:159], v14, s[28:31], s50 offen offset:1024 sc1
    v_add_f32 v168, 0x358637bd, v168
    v_add_f32 v184, 0x358637bd, v184
    v_rcp_f32 v168, v168
    v_rcp_f32 v184, v184
    v_pk_mul_f32 v[160:161], v[160:161], v[168:169] op_sel_hi:[1,0]
    v_pk_mul_f32 v[176:177], v[176:177], v[184:185] op_sel_hi:[1,0]
    v_pk_mul_f32 v[162:163], v[162:163], v[168:169] op_sel_hi:[1,0]
    v_pk_mul_f32 v[178:179], v[178:179], v[184:185] op_sel_hi:[1,0]
    v_pk_mul_f32 v[164:165], v[164:165], v[168:169] op_sel_hi:[1,0]
    v_pk_mul_f32 v[180:181], v[180:181], v[184:185] op_sel_hi:[1,0]
    v_pk_mul_f32 v[166:167], v[166:167], v[168:169] op_sel_hi:[1,0]
    v_pk_mul_f32 v[182:183], v[182:183], v[184:185] op_sel_hi:[1,0]
    v_cvt_pk_bf16_f32 v172, v160, v161
    v_cvt_pk_bf16_f32 v188, v176, v177
    v_cvt_pk_bf16_f32 v173, v162, v163
    v_cvt_pk_bf16_f32 v189, v178, v179
    v_cvt_pk_bf16_f32 v174, v164, v165
    v_cvt_pk_bf16_f32 v190, v180, v181
    v_cvt_pk_bf16_f32 v175, v166, v167
    v_cvt_pk_bf16_f32 v191, v182, v183
    buffer_store_dwordx4 v[172:175], v14, s[28:31], s50 offen offset:2048 sc1
    buffer_store_dwordx4 v[188:191], v14, s[28:31], s50 offen offset:3072 sc1
    ds_write_b128 v126, v[140:143] offset:0
    ds_write_b128 v126, v[156:159] offset:1024
    ds_write_b128 v126, v[172:175] offset:2048
    ds_write_b128 v126, v[188:191] offset:3072
    s_waitcnt lgkmcnt(0)
    s_barrier
    s_mov_b64 exec, 1
    s_waitcnt vmcnt(0)
    s_cbranch_scc1 K_os4a
    buffer_store_dword v112, v15, s[28:31], s58 offen sc1
    s_branch K_os4b
K_os4a:
    buffer_store_dword v112, v15, s[28:31], s58 offen
K_os4b:
    s_mov_b64 exec, -1
    s_branch K_end
K_kv:
    v_lshrrev_b32 v9, 5, v2
    s_mov_b32 s54, 0x3fb8aa3b
    s_mov_b32 s55, 0x3fb8aa3b
    s_mov_b32 s56, 0xbfb8aa3b
    v_and_b32 v3, 31, v2
    v_and_b32 v4, 15, v2
    v_lshrrev_b32 v5, 4, v2
    v_bfe_u32 v6, v2, 4, 1
    v_bfe_u32 v7, v2, 2, 2
    v_lshlrev_b32 v228, 4, v2
    v_lshrrev_b32 v10, 1, v4
    v_xor_b32 v10, v10, v5
    v_lshlrev_b32 v10, 4, v10
    v_lshl_add_u32 v224, v4, 7, v10
    v_xor_b32 v225, 64, v224
    v_bfe_u32 v10, v2, 3, 1
    v_lshl_or_b32 v10, v6, 1, v10
    v_xor_b32 v10, s9, v10
    v_lshlrev_b32 v10, 5, v10
    v_and_b32 v11, 3, v2
    v_lshl_add_u32 v10, v11, 3, v10
    v_lshl_add_u32 v10, v7, 7, v10
    v_lshl_add_u32 v10, v6, 11, v10
    v_lshl_add_u32 v10, v9, 13, v10
    v_add_u32 v226, 4096, v10
    v_lshl_add_u32 v10, v9, 3, v7
    v_lshlrev_b32 v10, 5, v10
    v_lshl_add_u32 v10, v6, 4, v10
    v_bfe_u32 v11, v2, 1, 1
    v_lshl_add_u32 v10, v11, 3, v10
    s_lshl_b32 s8, s9, 9
    s_add_u32 s8, s8, 161792
    v_add_u32 v227, s8, v10
    v_bfe_u32 v12, v2, 2, 1
    v_mul_u32_u24 v12, 0x8000, v12
    v_lshl_or_b32 v12, v12, 16, v12
    s_lshl_b32 s8, s5, 5
    s_lshl_b32 s57, s7, 2
    s_add_u32 s8, s8, s57
    s_add_u32 s8, s8, s9
    s_lshl_b32 s58, s8, 15
    s_add_u32 s58, s58, 0x400000
    s_lshl_b32 s62, s8, 12
    s_add_u32 s62, s62, 0x200000
    s_lshl_b32 s8, s6, 7
    s_add_u32 s59, s58, s8
    s_add_u32 s60, s59, 16384
    s_add_u32 s47, s62, s8
    s_lshl_b32 s8, s6, 11
    s_add_u32 s58, s58, s8
    v_lshlrev_b32 v10, 12, v5
    v_lshl_add_u32 v229, v4, 3, v10
    v_bfe_u32 v10, v2, 1, 1
    v_lshlrev_b32 v10, 3, v10
    v_lshl_add_u32 v10, v5, 1, v10
    v_and_b32 v11, 1, v2
    v_add_u32 v10, v10, v11
    v_lshlrev_b32 v10, 3, v10
    v_min_u32 v11, 1, v7
    v_lshl_or_b32 v230, v11, 30, v10
    v_bfe_i32 v245, v2, 0, 1
    v_bfe_i32 v246, v2, 1, 1
    v_lshlrev_b32 v252, 3, v2
    v_min_u32 v10, 1, v5
    v_lshl_or_b32 v253, v10, 30, v252
    v_subrev_u32 v254, 1, v10
    s_lshl_b32 s52, s9, 13
    v_bfe_u32 v10, v2, 1, 2
    v_lshlrev_b32 v11, 1, v9
    v_xor_b32 v10, v10, v11
    v_lshlrev_b32 v10, 4, v10
    v_lshl_add_u32 v10, v3, 6, v10
    v_add_u32 v231, s52, v10
    v_xor_b32 v232, 16, v231
    v_bfe_u32 v10, v2, 3, 1
    v_lshl_or_b32 v10, v6, 1, v10
    v_bfe_u32 v11, v2, 1, 1
    v_xor_b32 v10, v10, v11
    v_lshlrev_b32 v10, 4, v10
    v_and_b32 v11, 1, v2
    v_lshl_add_u32 v10, v11, 3, v10
    v_lshrrev_b32 v11, 2, v2
    v_lshl_add_u32 v10, v11, 6, v10
    v_add_u32 v233, s52, v10
    v_xor_b32 v234, 32, v233
    v_lshlrev_b32 v10, 8, v5
    v_lshl_add_u32 v235, v4, 3, v10
    v_add_u32 v10, s7, v2
    v_and_b32 v10, 7, v10
    v_lshlrev_b32 v237, 7, v10
    v_lshrrev_b32 v10, 3, v2
    v_min_u32 v10, 1, v10
    v_lshl_or_b32 v237, v10, 30, v237
    v_lshlrev_b32 v10, 4, v4
    v_lshl_add_u32 v11, v9, 10, v10
    v_lshl_add_u32 v11, v6, 3, v11
    s_add_u32 s8, s52, 4096
    v_add_u32 v238, s8, v11
    v_bfe_u32 v10, v2, 2, 1
    v_lshlrev_b32 v10, 10, v10
    v_bfe_u32 v11, v2, 3, 1
    v_lshl_add_u32 v10, v11, 9, v10
    v_and_b32 v11, 3, v2
    v_lshl_add_u32 v10, v11, 2, v10
    v_add_u32 v10, 256, v10
    v_lshlrev_b32 v11, 2, v2
    v_add_u32 v11, 3072, v11
    v_bfi_b32 v10, v254, v10, v11
    v_add_u32 v239, s8, v10
    v_and_b32 v10, 7, v2
    v_bfe_u32 v11, v2, 4, 1
    v_lshlrev_b32 v11, 1, v11
    v_xor_b32 v10, v10, v11
    v_lshlrev_b32 v10, 4, v10
    v_lshrrev_b32 v11, 3, v2
    v_lshl_add_u32 v240, v11, 10, v10
    v_lshl_add_u32 v10, v9, 2, v7
    v_lshlrev_b32 v10, 7, v10
    v_bfe_u32 v11, v2, 1, 1
    v_lshl_add_u32 v10, v11, 3, v10
    v_and_b32 v11, 1, v2
    v_lshl_or_b32 v11, v11, 2, v6
    v_bfe_u32 v13, v2, 3, 1
    v_lshlrev_b32 v13, 1, v13
    v_xor_b32 v11, v11, v13
    v_lshl_add_u32 v10, v11, 4, v10
    v_add_u32 v241, 32768, v10
    v_xor_b32 v242, 32, v241
    v_lshrrev_b32 v10, 3, v2
    v_lshlrev_b32 v10, 11, v10
    v_and_b32 v11, 7, v2
    v_lshl_add_u32 v243, v11, 4, v10
    v_mov_b32 v244, 6144
    v_mov_b32 v248, 0x3f803f80
    v_mov_b32 v249, 0x3f803f80
    v_mov_b32 v250, 0x3f803f80
    v_mov_b32 v251, 0x3f803f80
    s_lshl_b32 s8, s5, 6
    s_lshl_b32 s57, s6, 2
    s_add_u32 s8, s8, s57
    s_add_u32 s8, s8, s9
    s_lshl_b32 s37, s8, 15
    s_add_u32 s37, s37, 0x1000000
    s_lshl_b32 s38, s8, 10
    s_add_u32 s38, s38, 0x300000
    s_lshl_b32 s49, s6, 18
    s_lshl_b32 s8, s9, 16
    s_add_u32 s49, s49, s8
    s_lshl_b32 s8, s5, 10
    s_add_u32 s49, s49, s8
    s_add_u32 s49, s49, s46
    s_getreg_b32 s11, hwreg(HW_REG_XCC_ID, 0, 4)
    s_lshl_b32 s11, s11, 1
    s_lshl_b32 s8, s5, 4
    s_add_u32 s8, s8, s6
    s_lshl_b32 s53, s8, 10
    s_add_u32 s53, s53, 0x380000
    s_lshl_b32 s63, s67, 3
    s_add_u32 s63, s63, s9
    s_add_u32 s34, s7, 0
    s_lshl_b32 s35, s34, 3
    s_waitcnt lgkmcnt(0)
    s_mov_b32 s28, s44
    s_mov_b32 s29, s45
    s_mov_b32 s30, 0x10000000
    s_mov_b32 s31, 0x20000
    s_mov_b32 s24, s40
    s_mov_b32 s25, s41
    s_mov_b32 s26, 0x400000
    s_mov_b32 s27, 0x20000
    s_mov_b32 s20, s18
    s_mov_b32 s21, s19
    s_mov_b32 s22, 0x80000
    s_mov_b32 s23, 0x20000
    s_barrier
    ds_read_b64_tr_b16 v[128:129], v226 offset:0
    ds_read_b64_tr_b16 v[130:131], v226 offset:512
    ds_read_b64_tr_b16 v[132:133], v226 offset:1024
    ds_read_b64_tr_b16 v[134:135], v226 offset:1536
    ds_read_b128 v[16:19], v224 offset:0
    ds_read_b128 v[20:23], v224 offset:2048
    ds_read_b128 v[24:27], v224 offset:8192
    ds_read_b128 v[28:31], v224 offset:10240
    ds_read_b128 v[32:35], v224 offset:16384
    ds_read_b128 v[36:39], v224 offset:18432
    s_waitcnt lgkmcnt(4)
    v_mfma_f32_16x16x32_bf16 v[64:67], v[128:131], v[16:19], 0
    v_mfma_f32_16x16x32_bf16 v[96:99], v[16:19], v[132:135], 0
    ds_read_b128 v[40:43], v224 offset:24576
    v_mfma_f32_16x16x32_bf16 v[68:71], v[128:131], v[20:23], 0
    v_mfma_f32_16x16x32_bf16 v[100:103], v[20:23], v[132:135], 0
    ds_read_b128 v[44:47], v224 offset:26624
    s_waitcnt lgkmcnt(4)
    v_mfma_f32_16x16x32_bf16 v[72:75], v[128:131], v[24:27], 0
    ds_read_b64_tr_b16 v[136:137], v226 offset:16384
    ds_read_b64_tr_b16 v[138:139], v226 offset:16896
    v_mfma_f32_16x16x32_bf16 v[104:107], v[24:27], v[132:135], 0
    ds_read_b128 v[48:51], v225 offset:0
    v_mfma_f32_16x16x32_bf16 v[76:79], v[128:131], v[28:31], 0
    ds_read_b64_tr_b16 v[140:141], v226 offset:17408
    ds_read_b64_tr_b16 v[142:143], v226 offset:17920
    v_mfma_f32_16x16x32_bf16 v[108:111], v[28:31], v[132:135], 0
    ds_read_b128 v[52:55], v225 offset:2048
    s_waitcnt lgkmcnt(8)
    v_mfma_f32_16x16x32_bf16 v[80:83], v[128:131], v[32:35], 0
    v_mfma_f32_16x16x32_bf16 v[112:115], v[32:35], v[132:135], 0
    ds_read_b128 v[56:59], v225 offset:8192
    ds_read_b64_tr_b16 v[144:145], v227 offset:0
    ds_read_b64_tr_b16 v[146:147], v227 offset:128
    v_mfma_f32_16x16x32_bf16 v[84:87], v[128:131], v[36:39], 0
    v_mfma_f32_16x16x32_bf16 v[116:119], v[36:39], v[132:135], 0
    ds_read_b128 v[60:63], v225 offset:10240
    s_waitcnt lgkmcnt(10)
    v_mfma_f32_16x16x32_bf16 v[88:91], v[128:131], v[40:43], 0
    v_mfma_f32_16x16x32_bf16 v[120:123], v[40:43], v[132:135], 0
    ds_read_b128 v[16:19], v225 offset:16384
    v_mfma_f32_16x16x32_bf16 v[92:95], v[128:131], v[44:47], 0
    v_mfma_f32_16x16x32_bf16 v[124:127], v[44:47], v[132:135], 0
    ds_read_b128 v[20:23], v225 offset:18432
    s_waitcnt lgkmcnt(6)
    v_mfma_f32_16x16x32_bf16 v[64:67], v[136:139], v[48:51], v[64:67]
    v_mfma_f32_16x16x32_bf16 v[96:99], v[48:51], v[140:143], v[96:99]
    ds_read_b128 v[24:27], v225 offset:24576
    v_mfma_f32_16x16x32_bf16 v[68:71], v[136:139], v[52:55], v[68:71]
    v_mfma_f32_16x16x32_bf16 v[100:103], v[52:55], v[140:143], v[100:103]
    ds_read_b128 v[28:31], v225 offset:26624
    s_waitcnt lgkmcnt(0)
    s_barrier
    v_mfma_f32_16x16x32_bf16 v[72:75], v[136:139], v[56:59], v[72:75]
    ds_read_b64_tr_b16 v[128:129], v226 offset:32768
    ds_read_b64_tr_b16 v[130:131], v226 offset:33280
    v_mfma_f32_16x16x32_bf16 v[104:107], v[56:59], v[140:143], v[104:107]
    ds_read_b128 v[32:35], v224 offset:32768
    v_mfma_f32_16x16x32_bf16 v[76:79], v[136:139], v[60:63], v[76:79]
    ds_read_b64_tr_b16 v[132:133], v226 offset:33792
    ds_read_b64_tr_b16 v[134:135], v226 offset:34304
    v_mfma_f32_16x16x32_bf16 v[108:111], v[60:63], v[140:143], v[108:111]
    ds_read_b128 v[36:39], v224 offset:34816
    v_mfma_f32_16x16x32_bf16 v[80:83], v[136:139], v[16:19], v[80:83]
    v_mfma_f32_16x16x32_bf16 v[112:115], v[16:19], v[140:143], v[112:115]
    ds_read_b128 v[40:43], v224 offset:40960
    v_mfma_f32_16x16x32_bf16 v[84:87], v[136:139], v[20:23], v[84:87]
    v_mfma_f32_16x16x32_bf16 v[116:119], v[20:23], v[140:143], v[116:119]
    ds_read_b128 v[44:47], v224 offset:43008
    v_mfma_f32_16x16x32_bf16 v[88:91], v[136:139], v[24:27], v[88:91]
    v_mfma_f32_16x16x32_bf16 v[120:123], v[24:27], v[140:143], v[120:123]
    ds_read_b128 v[48:51], v224 offset:49152
    v_mfma_f32_16x16x32_bf16 v[92:95], v[136:139], v[28:31], v[92:95]
    v_mfma_f32_16x16x32_bf16 v[124:127], v[28:31], v[140:143], v[124:127]
    ds_read_b128 v[52:55], v224 offset:51200
    s_waitcnt lgkmcnt(4)
    v_mfma_f32_16x16x32_bf16 v[64:67], v[128:131], v[32:35], v[64:67]
    v_mfma_f32_16x16x32_bf16 v[96:99], v[32:35], v[132:135], v[96:99]
    ds_read_b128 v[56:59], v224 offset:57344
    v_mfma_f32_16x16x32_bf16 v[68:71], v[128:131], v[36:39], v[68:71]
    v_mfma_f32_16x16x32_bf16 v[100:103], v[36:39], v[132:135], v[100:103]
    ds_read_b128 v[60:63], v224 offset:59392
    s_waitcnt lgkmcnt(4)
    v_mfma_f32_16x16x32_bf16 v[72:75], v[128:131], v[40:43], v[72:75]
    ds_read_b64_tr_b16 v[136:137], v226 offset:49152
    ds_read_b64_tr_b16 v[138:139], v226 offset:49664
    v_mfma_f32_16x16x32_bf16 v[104:107], v[40:43], v[132:135], v[104:107]
    ds_read_b128 v[16:19], v225 offset:32768
    v_mfma_f32_16x16x32_bf16 v[76:79], v[128:131], v[44:47], v[76:79]
    ds_read_b64_tr_b16 v[140:141], v226 offset:50176
    ds_read_b64_tr_b16 v[142:143], v226 offset:50688
    v_mfma_f32_16x16x32_bf16 v[108:111], v[44:47], v[132:135], v[108:111]
    ds_read_b128 v[20:23], v225 offset:34816
    s_waitcnt lgkmcnt(8)
    v_mfma_f32_16x16x32_bf16 v[80:83], v[128:131], v[48:51], v[80:83]
    v_mfma_f32_16x16x32_bf16 v[112:115], v[48:51], v[132:135], v[112:115]
    ds_read_b128 v[24:27], v225 offset:40960
    v_xor_b32 v144, v12, v144
    v_xor_b32 v145, v12, v145
    v_xor_b32 v146, v12, v146
    v_xor_b32 v147, v12, v147
    v_mfma_f32_16x16x32_bf16 v[84:87], v[128:131], v[52:55], v[84:87]
    v_mfma_f32_16x16x32_bf16 v[116:119], v[52:55], v[132:135], v[116:119]
    ds_read_b128 v[28:31], v225 offset:43008
    s_waitcnt lgkmcnt(8)
    v_mfma_f32_16x16x32_bf16 v[88:91], v[128:131], v[56:59], v[88:91]
    v_mfma_f32_16x16x32_bf16 v[120:123], v[56:59], v[132:135], v[120:123]
    ds_read_b128 v[32:35], v225 offset:49152
    v_mfma_f32_16x16x32_bf16 v[92:95], v[128:131], v[60:63], v[92:95]
    v_mfma_f32_16x16x32_bf16 v[124:127], v[60:63], v[132:135], v[124:127]
    ds_read_b128 v[36:39], v225 offset:51200
    s_waitcnt lgkmcnt(4)
    v_mfma_f32_16x16x32_bf16 v[64:67], v[136:139], v[16:19], v[64:67]
    v_mfma_f32_16x16x32_bf16 v[96:99], v[16:19], v[140:143], v[96:99]
    ds_read_b128 v[40:43], v225 offset:57344
    v_mfma_f32_16x16x32_bf16 v[68:71], v[136:139], v[20:23], v[68:71]
    v_mfma_f32_16x16x32_bf16 v[100:103], v[20:23], v[140:143], v[100:103]
    ds_read_b128 v[44:47], v225 offset:59392
    v_add_u32 v224, 0x10000, v224
    v_add_u32 v225, 0x10000, v225
    v_add_u32 v226, 0x10000, v226
    s_barrier
    s_waitcnt lgkmcnt(4)
    v_mfma_f32_16x16x32_bf16 v[72:75], v[136:139], v[24:27], v[72:75]
    ds_read_b64_tr_b16 v[128:129], v226 offset:0
    ds_read_b64_tr_b16 v[130:131], v226 offset:512
    v_mfma_f32_16x16x32_bf16 v[104:107], v[24:27], v[140:143], v[104:107]
    ds_read_b128 v[48:51], v224 offset:0
    v_mfma_f32_16x16x32_bf16 v[76:79], v[136:139], v[28:31], v[76:79]
    ds_read_b64_tr_b16 v[132:133], v226 offset:1024
    ds_read_b64_tr_b16 v[134:135], v226 offset:1536
    v_mfma_f32_16x16x32_bf16 v[108:111], v[28:31], v[140:143], v[108:111]
    ds_read_b128 v[52:55], v224 offset:2048
    s_waitcnt lgkmcnt(8)
    v_mfma_f32_16x16x32_bf16 v[80:83], v[136:139], v[32:35], v[80:83]
    v_mfma_f32_16x16x32_bf16 v[112:115], v[32:35], v[140:143], v[112:115]
    ds_read_b128 v[56:59], v224 offset:8192
    v_mfma_f32_16x16x32_bf16 v[84:87], v[136:139], v[36:39], v[84:87]
    v_mfma_f32_16x16x32_bf16 v[116:119], v[36:39], v[140:143], v[116:119]
    ds_read_b128 v[60:63], v224 offset:10240
    s_waitcnt lgkmcnt(8)
    v_mfma_f32_16x16x32_bf16 v[88:91], v[136:139], v[40:43], v[88:91]
    v_mfma_f32_16x16x32_bf16 v[120:123], v[40:43], v[140:143], v[120:123]
    ds_read_b128 v[16:19], v224 offset:16384
    v_mfma_f32_16x16x32_bf16 v[92:95], v[136:139], v[44:47], v[92:95]
    v_mfma_f32_16x16x32_bf16 v[124:127], v[44:47], v[140:143], v[124:127]
    ds_read_b128 v[20:23], v224 offset:18432
    s_waitcnt lgkmcnt(4)
    v_mfma_f32_16x16x32_bf16 v[64:67], v[128:131], v[48:51], v[64:67]
    v_mfma_f32_16x16x32_bf16 v[96:99], v[48:51], v[132:135], v[96:99]
    ds_read_b128 v[24:27], v224 offset:24576
    v_mfma_f32_16x16x32_bf16 v[68:71], v[128:131], v[52:55], v[68:71]
    v_mfma_f32_16x16x32_bf16 v[100:103], v[52:55], v[132:135], v[100:103]
    ds_read_b128 v[28:31], v224 offset:26624
    s_waitcnt lgkmcnt(4)
    v_mfma_f32_16x16x32_bf16 v[72:75], v[128:131], v[56:59], v[72:75]
    ds_read_b64_tr_b16 v[136:137], v226 offset:16384
    ds_read_b64_tr_b16 v[138:139], v226 offset:16896
    v_mfma_f32_16x16x32_bf16 v[104:107], v[56:59], v[132:135], v[104:107]
    ds_read_b128 v[32:35], v225 offset:0
    v_mfma_f32_16x16x32_bf16 v[76:79], v[128:131], v[60:63], v[76:79]
    ds_read_b64_tr_b16 v[140:141], v226 offset:17408
    ds_read_b64_tr_b16 v[142:143], v226 offset:17920
    v_mfma_f32_16x16x32_bf16 v[108:111], v[60:63], v[132:135], v[108:111]
    ds_read_b128 v[36:39], v225 offset:2048
    s_waitcnt lgkmcnt(8)
    v_mfma_f32_16x16x32_bf16 v[80:83], v[128:131], v[16:19], v[80:83]
    v_mfma_f32_16x16x32_bf16 v[112:115], v[16:19], v[132:135], v[112:115]
    ds_read_b128 v[40:43], v225 offset:8192
    v_mfma_f32_16x16x32_bf16 v[84:87], v[128:131], v[20:23], v[84:87]
    v_mfma_f32_16x16x32_bf16 v[116:119], v[20:23], v[132:135], v[116:119]
    ds_read_b128 v[44:47], v225 offset:10240
    s_waitcnt lgkmcnt(8)
    v_mfma_f32_16x16x32_bf16 v[88:91], v[128:131], v[24:27], v[88:91]
    v_mfma_f32_16x16x32_bf16 v[120:123], v[24:27], v[132:135], v[120:123]
    ds_read_b128 v[48:51], v225 offset:16384
    v_mfma_f32_16x16x32_bf16 v[92:95], v[128:131], v[28:31], v[92:95]
    v_mfma_f32_16x16x32_bf16 v[124:127], v[28:31], v[132:135], v[124:127]
    ds_read_b128 v[52:55], v225 offset:18432
    s_waitcnt lgkmcnt(4)
    v_mfma_f32_16x16x32_bf16 v[64:67], v[136:139], v[32:35], v[64:67]
    v_mfma_f32_16x16x32_bf16 v[96:99], v[32:35], v[140:143], v[96:99]
    ds_read_b128 v[56:59], v225 offset:24576
    v_mfma_f32_16x16x32_bf16 v[68:71], v[136:139], v[36:39], v[68:71]
    v_mfma_f32_16x16x32_bf16 v[100:103], v[36:39], v[140:143], v[100:103]
    ds_read_b128 v[60:63], v225 offset:26624
    s_barrier
    s_waitcnt lgkmcnt(4)
    v_mfma_f32_16x16x32_bf16 v[72:75], v[136:139], v[40:43], v[72:75]
    ds_read_b64_tr_b16 v[128:129], v226 offset:32768
    ds_read_b64_tr_b16 v[130:131], v226 offset:33280
    v_mfma_f32_16x16x32_bf16 v[104:107], v[40:43], v[140:143], v[104:107]
    ds_read_b128 v[16:19], v224 offset:32768
    v_mfma_f32_16x16x32_bf16 v[76:79], v[136:139], v[44:47], v[76:79]
    ds_read_b64_tr_b16 v[132:133], v226 offset:33792
    ds_read_b64_tr_b16 v[134:135], v226 offset:34304
    v_mfma_f32_16x16x32_bf16 v[108:111], v[44:47], v[140:143], v[108:111]
    ds_read_b128 v[20:23], v224 offset:34816
    s_waitcnt lgkmcnt(8)
    v_mfma_f32_16x16x32_bf16 v[80:83], v[136:139], v[48:51], v[80:83]
    v_mfma_f32_16x16x32_bf16 v[112:115], v[48:51], v[140:143], v[112:115]
    ds_read_b128 v[24:27], v224 offset:40960
    v_mfma_f32_16x16x32_bf16 v[84:87], v[136:139], v[52:55], v[84:87]
    v_mfma_f32_16x16x32_bf16 v[116:119], v[52:55], v[140:143], v[116:119]
    ds_read_b128 v[28:31], v224 offset:43008
    s_waitcnt lgkmcnt(8)
    v_mfma_f32_16x16x32_bf16 v[88:91], v[136:139], v[56:59], v[88:91]
    v_mfma_f32_16x16x32_bf16 v[120:123], v[56:59], v[140:143], v[120:123]
    ds_read_b128 v[32:35], v224 offset:49152
    v_mfma_f32_16x16x32_bf16 v[92:95], v[136:139], v[60:63], v[92:95]
    v_mfma_f32_16x16x32_bf16 v[124:127], v[60:63], v[140:143], v[124:127]
    ds_read_b128 v[36:39], v224 offset:51200
    s_waitcnt lgkmcnt(4)
    v_mfma_f32_16x16x32_bf16 v[64:67], v[128:131], v[16:19], v[64:67]
    v_mfma_f32_16x16x32_bf16 v[96:99], v[16:19], v[132:135], v[96:99]
    ds_read_b128 v[40:43], v224 offset:57344
    v_mfma_f32_16x16x32_bf16 v[68:71], v[128:131], v[20:23], v[68:71]
    v_mfma_f32_16x16x32_bf16 v[100:103], v[20:23], v[132:135], v[100:103]
    ds_read_b128 v[44:47], v224 offset:59392
    s_waitcnt lgkmcnt(4)
    v_mfma_f32_16x16x32_bf16 v[72:75], v[128:131], v[24:27], v[72:75]
    ds_read_b64_tr_b16 v[136:137], v226 offset:49152
    ds_read_b64_tr_b16 v[138:139], v226 offset:49664
    v_mfma_f32_16x16x32_bf16 v[104:107], v[24:27], v[132:135], v[104:107]
    ds_read_b128 v[48:51], v225 offset:32768
    v_mfma_f32_16x16x32_bf16 v[76:79], v[128:131], v[28:31], v[76:79]
    ds_read_b64_tr_b16 v[140:141], v226 offset:50176
    ds_read_b64_tr_b16 v[142:143], v226 offset:50688
    v_mfma_f32_16x16x32_bf16 v[108:111], v[28:31], v[132:135], v[108:111]
    ds_read_b128 v[52:55], v225 offset:34816
    s_waitcnt lgkmcnt(8)
    v_mfma_f32_16x16x32_bf16 v[80:83], v[128:131], v[32:35], v[80:83]
    v_mfma_f32_16x16x32_bf16 v[112:115], v[32:35], v[132:135], v[112:115]
    ds_read_b128 v[56:59], v225 offset:40960
    v_mfma_f32_16x16x32_bf16 v[84:87], v[128:131], v[36:39], v[84:87]
    v_mfma_f32_16x16x32_bf16 v[116:119], v[36:39], v[132:135], v[116:119]
    ds_read_b128 v[60:63], v225 offset:43008
    s_waitcnt lgkmcnt(8)
    v_mfma_f32_16x16x32_bf16 v[88:91], v[128:131], v[40:43], v[88:91]
    v_mfma_f32_16x16x32_bf16 v[120:123], v[40:43], v[132:135], v[120:123]
    ds_read_b128 v[16:19], v225 offset:49152
    v_mfma_f32_16x16x32_bf16 v[92:95], v[128:131], v[44:47], v[92:95]
    v_mfma_f32_16x16x32_bf16 v[124:127], v[44:47], v[132:135], v[124:127]
    ds_read_b128 v[20:23], v225 offset:51200
    s_waitcnt lgkmcnt(4)
    v_mfma_f32_16x16x32_bf16 v[64:67], v[136:139], v[48:51], v[64:67]
    v_mfma_f32_16x16x32_bf16 v[96:99], v[48:51], v[140:143], v[96:99]
    ds_read_b128 v[24:27], v225 offset:57344
    v_mfma_f32_16x16x32_bf16 v[68:71], v[136:139], v[52:55], v[68:71]
    v_mfma_f32_16x16x32_bf16 v[100:103], v[52:55], v[140:143], v[100:103]
    ds_read_b128 v[28:31], v225 offset:59392
    v_add_u32 v224, 0x10000, v224
    v_add_u32 v225, 0x10000, v225
    v_add_u32 v226, 0x10000, v226
    s_barrier
    s_waitcnt lgkmcnt(4)
    v_mfma_f32_16x16x32_bf16 v[72:75], v[136:139], v[56:59], v[72:75]
    ds_read_b64_tr_b16 v[128:129], v226 offset:0
    ds_read_b64_tr_b16 v[130:131], v226 offset:512
    v_mfma_f32_16x16x32_bf16 v[104:107], v[56:59], v[140:143], v[104:107]
    ds_read_b128 v[32:35], v224 offset:0
    v_mfma_f32_16x16x32_bf16 v[76:79], v[136:139], v[60:63], v[76:79]
    ds_read_b64_tr_b16 v[132:133], v226 offset:1024
    ds_read_b64_tr_b16 v[134:135], v226 offset:1536
    v_mfma_f32_16x16x32_bf16 v[108:111], v[60:63], v[140:143], v[108:111]
    ds_read_b128 v[36:39], v224 offset:2048
    s_waitcnt lgkmcnt(8)
    v_mfma_f32_16x16x32_bf16 v[80:83], v[136:139], v[16:19], v[80:83]
    v_mfma_f32_16x16x32_bf16 v[112:115], v[16:19], v[140:143], v[112:115]
    ds_read_b128 v[40:43], v224 offset:8192
    v_mfma_f32_16x16x32_bf16 v[84:87], v[136:139], v[20:23], v[84:87]
    v_mfma_f32_16x16x32_bf16 v[116:119], v[20:23], v[140:143], v[116:119]
    ds_read_b128 v[44:47], v224 offset:10240
    s_waitcnt lgkmcnt(8)
    v_mfma_f32_16x16x32_bf16 v[88:91], v[136:139], v[24:27], v[88:91]
    v_mfma_f32_16x16x32_bf16 v[120:123], v[24:27], v[140:143], v[120:123]
    ds_read_b128 v[48:51], v224 offset:16384
    v_mfma_f32_16x16x32_bf16 v[92:95], v[136:139], v[28:31], v[92:95]
    v_mfma_f32_16x16x32_bf16 v[124:127], v[28:31], v[140:143], v[124:127]
    ds_read_b128 v[52:55], v224 offset:18432
    s_waitcnt lgkmcnt(4)
    v_mfma_f32_16x16x32_bf16 v[64:67], v[128:131], v[32:35], v[64:67]
    v_mfma_f32_16x16x32_bf16 v[96:99], v[32:35], v[132:135], v[96:99]
    ds_read_b128 v[56:59], v224 offset:24576
    v_mfma_f32_16x16x32_bf16 v[68:71], v[128:131], v[36:39], v[68:71]
    v_mfma_f32_16x16x32_bf16 v[100:103], v[36:39], v[132:135], v[100:103]
    ds_read_b128 v[60:63], v224 offset:26624
    s_waitcnt lgkmcnt(4)
    v_mfma_f32_16x16x32_bf16 v[72:75], v[128:131], v[40:43], v[72:75]
    ds_read_b64_tr_b16 v[136:137], v226 offset:16384
    ds_read_b64_tr_b16 v[138:139], v226 offset:16896
    v_mfma_f32_16x16x32_bf16 v[104:107], v[40:43], v[132:135], v[104:107]
    ds_read_b128 v[16:19], v225 offset:0
    v_mfma_f32_16x16x32_bf16 v[76:79], v[128:131], v[44:47], v[76:79]
    ds_read_b64_tr_b16 v[140:141], v226 offset:17408
    ds_read_b64_tr_b16 v[142:143], v226 offset:17920
    v_mfma_f32_16x16x32_bf16 v[108:111], v[44:47], v[132:135], v[108:111]
    ds_read_b128 v[20:23], v225 offset:2048
    s_waitcnt lgkmcnt(8)
    v_mfma_f32_16x16x32_bf16 v[80:83], v[128:131], v[48:51], v[80:83]
    v_mfma_f32_16x16x32_bf16 v[112:115], v[48:51], v[132:135], v[112:115]
    ds_read_b128 v[24:27], v225 offset:8192
    v_mfma_f32_16x16x32_bf16 v[84:87], v[128:131], v[52:55], v[84:87]
    v_mfma_f32_16x16x32_bf16 v[116:119], v[52:55], v[132:135], v[116:119]
    ds_read_b128 v[28:31], v225 offset:10240
    s_waitcnt lgkmcnt(8)
    v_mfma_f32_16x16x32_bf16 v[88:91], v[128:131], v[56:59], v[88:91]
    v_mfma_f32_16x16x32_bf16 v[120:123], v[56:59], v[132:135], v[120:123]
    ds_read_b128 v[32:35], v225 offset:16384
    v_mfma_f32_16x16x32_bf16 v[92:95], v[128:131], v[60:63], v[92:95]
    v_mfma_f32_16x16x32_bf16 v[124:127], v[60:63], v[132:135], v[124:127]
    ds_read_b128 v[36:39], v225 offset:18432
    s_waitcnt lgkmcnt(4)
    v_mfma_f32_16x16x32_bf16 v[64:67], v[136:139], v[16:19], v[64:67]
    v_mfma_f32_16x16x32_bf16 v[96:99], v[16:19], v[140:143], v[96:99]
    ds_read_b128 v[40:43], v225 offset:24576
    v_mfma_f32_16x16x32_bf16 v[68:71], v[136:139], v[20:23], v[68:71]
    v_mfma_f32_16x16x32_bf16 v[100:103], v[20:23], v[140:143], v[100:103]
    ds_read_b128 v[44:47], v225 offset:26624
    v_add_u32 v224, 0xfffe0000, v224
    v_add_u32 v225, 0xfffe0000, v225
    v_add_u32 v226, 0xfffe0000, v226
    s_barrier
    s_waitcnt lgkmcnt(4)
    v_mfma_f32_16x16x32_bf16 v[72:75], v[136:139], v[24:27], v[72:75]
    ds_read_b64_tr_b16 v[128:129], v226 offset:0
    ds_read_b64_tr_b16 v[130:131], v226 offset:512
    v_mfma_f32_16x16x32_bf16 v[104:107], v[24:27], v[140:143], v[104:107]
    ds_read_b128 v[48:51], v224 offset:0
    v_mfma_f32_16x16x32_bf16 v[76:79], v[136:139], v[28:31], v[76:79]
    ds_read_b64_tr_b16 v[132:133], v226 offset:1024
    ds_read_b64_tr_b16 v[134:135], v226 offset:1536
    v_mfma_f32_16x16x32_bf16 v[108:111], v[28:31], v[140:143], v[108:111]
    ds_read_b128 v[52:55], v224 offset:2048
    s_waitcnt lgkmcnt(8)
    v_mfma_f32_16x16x32_bf16 v[80:83], v[136:139], v[32:35], v[80:83]
    v_mfma_f32_16x16x32_bf16 v[112:115], v[32:35], v[140:143], v[112:115]
    ds_read_b128 v[56:59], v224 offset:8192
    v_mfma_f32_16x16x32_bf16 v[84:87], v[136:139], v[36:39], v[84:87]
    v_mfma_f32_16x16x32_bf16 v[116:119], v[36:39], v[140:143], v[116:119]
    ds_read_b128 v[60:63], v224 offset:10240
    s_waitcnt lgkmcnt(8)
    v_mfma_f32_16x16x32_bf16 v[88:91], v[136:139], v[40:43], v[88:91]
    v_mfma_f32_16x16x32_bf16 v[120:123], v[40:43], v[140:143], v[120:123]
    ds_read_b128 v[16:19], v224 offset:16384
    v_mfma_f32_16x16x32_bf16 v[92:95], v[136:139], v[44:47], v[92:95]
    v_mfma_f32_16x16x32_bf16 v[124:127], v[44:47], v[140:143], v[124:127]
    ds_read_b128 v[20:23], v224 offset:18432
    s_waitcnt lgkmcnt(4)
    v_mfma_f32_16x16x32_bf16 v[64:67], v[128:131], v[48:51], v[64:67]
    v_mfma_f32_16x16x32_bf16 v[96:99], v[48:51], v[132:135], v[96:99]
    ds_read_b128 v[24:27], v224 offset:24576
    v_mfma_f32_16x16x32_bf16 v[68:71], v[128:131], v[52:55], v[68:71]
    v_mfma_f32_16x16x32_bf16 v[100:103], v[52:55], v[132:135], v[100:103]
    ds_read_b128 v[28:31], v224 offset:26624
    s_waitcnt lgkmcnt(4)
    v_mfma_f32_16x16x32_bf16 v[72:75], v[128:131], v[56:59], v[72:75]
    ds_read_b64_tr_b16 v[136:137], v226 offset:16384
    ds_read_b64_tr_b16 v[138:139], v226 offset:16896
    v_mfma_f32_16x16x32_bf16 v[104:107], v[56:59], v[132:135], v[104:107]
    ds_read_b128 v[32:35], v225 offset:0
    v_mfma_f32_16x16x32_bf16 v[76:79], v[128:131], v[60:63], v[76:79]
    ds_read_b64_tr_b16 v[140:141], v226 offset:17408
    ds_read_b64_tr_b16 v[142:143], v226 offset:17920
    v_mfma_f32_16x16x32_bf16 v[108:111], v[60:63], v[132:135], v[108:111]
    ds_read_b128 v[36:39], v225 offset:2048
    s_waitcnt lgkmcnt(8)
    v_mfma_f32_16x16x32_bf16 v[80:83], v[128:131], v[16:19], v[80:83]
    v_mfma_f32_16x16x32_bf16 v[112:115], v[16:19], v[132:135], v[112:115]
    ds_read_b128 v[40:43], v225 offset:8192
    v_mfma_f32_16x16x32_bf16 v[84:87], v[128:131], v[20:23], v[84:87]
    v_mfma_f32_16x16x32_bf16 v[116:119], v[20:23], v[132:135], v[116:119]
    ds_read_b128 v[44:47], v225 offset:10240
    s_waitcnt lgkmcnt(8)
    v_mfma_f32_16x16x32_bf16 v[88:91], v[128:131], v[24:27], v[88:91]
    v_mfma_f32_16x16x32_bf16 v[120:123], v[24:27], v[132:135], v[120:123]
    ds_read_b128 v[48:51], v225 offset:16384
    v_mfma_f32_16x16x32_bf16 v[92:95], v[128:131], v[28:31], v[92:95]
    v_mfma_f32_16x16x32_bf16 v[124:127], v[28:31], v[132:135], v[124:127]
    ds_read_b128 v[52:55], v225 offset:18432
    s_waitcnt lgkmcnt(4)
    v_mfma_f32_16x16x32_bf16 v[64:67], v[136:139], v[32:35], v[64:67]
    v_mfma_f32_16x16x32_bf16 v[96:99], v[32:35], v[140:143], v[96:99]
    ds_read_b128 v[56:59], v225 offset:24576
    v_mfma_f32_16x16x32_bf16 v[68:71], v[136:139], v[36:39], v[68:71]
    v_mfma_f32_16x16x32_bf16 v[100:103], v[36:39], v[140:143], v[100:103]
    ds_read_b128 v[60:63], v225 offset:26624
    s_waitcnt lgkmcnt(0)
    s_barrier
    v_mfma_f32_16x16x32_bf16 v[72:75], v[136:139], v[40:43], v[72:75]
    ds_read_b64_tr_b16 v[128:129], v226 offset:32768
    ds_read_b64_tr_b16 v[130:131], v226 offset:33280
    v_mfma_f32_16x16x32_bf16 v[104:107], v[40:43], v[140:143], v[104:107]
    ds_read_b128 v[16:19], v224 offset:32768
    v_mfma_f32_16x16x32_bf16 v[76:79], v[136:139], v[44:47], v[76:79]
    ds_read_b64_tr_b16 v[132:133], v226 offset:33792
    ds_read_b64_tr_b16 v[134:135], v226 offset:34304
    v_mfma_f32_16x16x32_bf16 v[108:111], v[44:47], v[140:143], v[108:111]
    ds_read_b128 v[20:23], v224 offset:34816
    v_mfma_f32_16x16x32_bf16 v[80:83], v[136:139], v[48:51], v[80:83]
    v_mfma_f32_16x16x32_bf16 v[112:115], v[48:51], v[140:143], v[112:115]
    ds_read_b128 v[24:27], v224 offset:40960
    v_mfma_f32_16x16x32_bf16 v[84:87], v[136:139], v[52:55], v[84:87]
    v_mfma_f32_16x16x32_bf16 v[116:119], v[52:55], v[140:143], v[116:119]
    ds_read_b128 v[28:31], v224 offset:43008
    v_mfma_f32_16x16x32_bf16 v[88:91], v[136:139], v[56:59], v[88:91]
    v_mfma_f32_16x16x32_bf16 v[120:123], v[56:59], v[140:143], v[120:123]
    ds_read_b128 v[32:35], v224 offset:49152
    v_mfma_f32_16x16x32_bf16 v[92:95], v[136:139], v[60:63], v[92:95]
    v_mfma_f32_16x16x32_bf16 v[124:127], v[60:63], v[140:143], v[124:127]
    ds_read_b128 v[36:39], v224 offset:51200
    s_waitcnt lgkmcnt(4)
    v_mfma_f32_16x16x32_bf16 v[64:67], v[128:131], v[16:19], v[64:67]
    v_mfma_f32_16x16x32_bf16 v[96:99], v[16:19], v[132:135], v[96:99]
    ds_read_b128 v[40:43], v224 offset:57344
    v_mfma_f32_16x16x32_bf16 v[68:71], v[128:131], v[20:23], v[68:71]
    v_mfma_f32_16x16x32_bf16 v[100:103], v[20:23], v[132:135], v[100:103]
    ds_read_b128 v[44:47], v224 offset:59392
    s_waitcnt lgkmcnt(4)
    v_mfma_f32_16x16x32_bf16 v[72:75], v[128:131], v[24:27], v[72:75]
    ds_read_b64_tr_b16 v[136:137], v226 offset:49152
    ds_read_b64_tr_b16 v[138:139], v226 offset:49664
    v_mfma_f32_16x16x32_bf16 v[104:107], v[24:27], v[132:135], v[104:107]
    ds_read_b128 v[48:51], v225 offset:32768
    v_mfma_f32_16x16x32_bf16 v[76:79], v[128:131], v[28:31], v[76:79]
    ds_read_b64_tr_b16 v[140:141], v226 offset:50176
    ds_read_b64_tr_b16 v[142:143], v226 offset:50688
    v_mfma_f32_16x16x32_bf16 v[108:111], v[28:31], v[132:135], v[108:111]
    ds_read_b128 v[52:55], v225 offset:34816
    s_waitcnt lgkmcnt(8)
    v_mfma_f32_16x16x32_bf16 v[80:83], v[128:131], v[32:35], v[80:83]
    v_mfma_f32_16x16x32_bf16 v[112:115], v[32:35], v[132:135], v[112:115]
    ds_read_b128 v[56:59], v225 offset:40960
    v_mfma_f32_16x16x32_bf16 v[84:87], v[128:131], v[36:39], v[84:87]
    v_mfma_f32_16x16x32_bf16 v[116:119], v[36:39], v[132:135], v[116:119]
    ds_read_b128 v[60:63], v225 offset:43008
    s_waitcnt lgkmcnt(8)
    v_mfma_f32_16x16x32_bf16 v[88:91], v[128:131], v[40:43], v[88:91]
    v_mfma_f32_16x16x32_bf16 v[120:123], v[40:43], v[132:135], v[120:123]
    ds_read_b128 v[16:19], v225 offset:49152
    v_mfma_f32_16x16x32_bf16 v[92:95], v[128:131], v[44:47], v[92:95]
    v_mfma_f32_16x16x32_bf16 v[124:127], v[44:47], v[132:135], v[124:127]
    ds_read_b128 v[20:23], v225 offset:51200
    s_waitcnt lgkmcnt(4)
    v_mfma_f32_16x16x32_bf16 v[64:67], v[136:139], v[48:51], v[64:67]
    v_mfma_f32_16x16x32_bf16 v[96:99], v[48:51], v[140:143], v[96:99]
    ds_read_b128 v[24:27], v225 offset:57344
    v_mfma_f32_16x16x32_bf16 v[68:71], v[136:139], v[52:55], v[68:71]
    v_mfma_f32_16x16x32_bf16 v[100:103], v[52:55], v[140:143], v[100:103]
    ds_read_b128 v[28:31], v225 offset:59392
    s_waitcnt lgkmcnt(4)
    v_mfma_f32_16x16x32_bf16 v[72:75], v[136:139], v[56:59], v[72:75]
    v_mfma_f32_16x16x32_bf16 v[104:107], v[56:59], v[140:143], v[104:107]
    v_mfma_f32_16x16x32_bf16 v[76:79], v[136:139], v[60:63], v[76:79]
    v_mfma_f32_16x16x32_bf16 v[108:111], v[60:63], v[140:143], v[108:111]
    s_waitcnt lgkmcnt(2)
    v_mfma_f32_16x16x32_bf16 v[80:83], v[136:139], v[16:19], v[80:83]
    v_mfma_f32_16x16x32_bf16 v[112:115], v[16:19], v[140:143], v[112:115]
    v_mfma_f32_16x16x32_bf16 v[84:87], v[136:139], v[20:23], v[84:87]
    v_mfma_f32_16x16x32_bf16 v[116:119], v[20:23], v[140:143], v[116:119]
    s_waitcnt lgkmcnt(0)
    v_mfma_f32_16x16x32_bf16 v[88:91], v[136:139], v[24:27], v[88:91]
    v_add_u32 v224, 0x10000, v224
    v_add_u32 v225, 0x10000, v225
    v_add_u32 v226, 0x10000, v226
    v_mfma_f32_16x16x32_bf16 v[120:123], v[24:27], v[140:143], v[120:123]
    v_mfma_f32_16x16x32_bf16 v[92:95], v[136:139], v[28:31], v[92:95]
    v_mfma_f32_16x16x32_bf16 v[124:127], v[28:31], v[140:143], v[124:127]
    s_barrier
    ds_read_b64_tr_b16 v[128:129], v226 offset:0
    ds_read_b64_tr_b16 v[130:131], v226 offset:512
    ds_read_b128 v[160:163], v224 offset:0
    ds_read_b128 v[164:167], v224 offset:2048
    ds_read_b128 v[168:171], v224 offset:8192
    ds_read_b128 v[172:175], v224 offset:10240
    ds_read_b128 v[176:179], v224 offset:16384
    ds_read_b128 v[180:183], v224 offset:18432
    ds_read_b128 v[184:187], v224 offset:24576
    ds_read_b128 v[188:191], v224 offset:26624
    ds_read_b64_tr_b16 v[136:137], v226 offset:16384
    ds_read_b64_tr_b16 v[138:139], v226 offset:16896
    s_waitcnt lgkmcnt(8)
    v_mfma_f32_16x16x32_bf16 v[64:67], v[128:131], v[160:163], v[64:67]
    ds_read_b128 v[192:195], v225 offset:0
    v_mfma_f32_16x16x32_bf16 v[68:71], v[128:131], v[164:167], v[68:71]
    ds_read_b128 v[196:199], v225 offset:2048
    s_waitcnt lgkmcnt(8)
    v_mfma_f32_16x16x32_bf16 v[72:75], v[128:131], v[168:171], v[72:75]
    ds_read_b128 v[200:203], v225 offset:8192
    v_mfma_f32_16x16x32_bf16 v[76:79], v[128:131], v[172:175], v[76:79]
    ds_read_b128 v[204:207], v225 offset:10240
    s_waitcnt lgkmcnt(8)
    v_mfma_f32_16x16x32_bf16 v[80:83], v[128:131], v[176:179], v[80:83]
    ds_read_b128 v[208:211], v225 offset:16384
    v_mfma_f32_16x16x32_bf16 v[84:87], v[128:131], v[180:183], v[84:87]
    ds_read_b128 v[212:215], v225 offset:18432
    s_waitcnt lgkmcnt(8)
    v_mfma_f32_16x16x32_bf16 v[88:91], v[128:131], v[184:187], v[88:91]
    ds_read_b128 v[216:219], v225 offset:24576
    v_mfma_f32_16x16x32_bf16 v[92:95], v[128:131], v[188:191], v[92:95]
    ds_read_b128 v[220:223], v225 offset:26624
    s_waitcnt lgkmcnt(6)
    v_mfma_f32_16x16x32_bf16 v[64:67], v[136:139], v[192:195], v[64:67]
    ds_read_b64_tr_b16 v[132:133], v226 offset:1024
    ds_read_b64_tr_b16 v[134:135], v226 offset:1536
    v_mfma_f32_16x16x32_bf16 v[68:71], v[136:139], v[196:199], v[68:71]
    ds_read_b64_tr_b16 v[140:141], v226 offset:17408
    ds_read_b64_tr_b16 v[142:143], v226 offset:17920
    s_waitcnt lgkmcnt(0)
    v_mfma_f32_16x16x32_bf16 v[72:75], v[136:139], v[200:203], v[72:75]
    ds_read_b32 v149, v244
    v_mfma_f32_16x16x32_bf16 v[76:79], v[136:139], v[204:207], v[76:79]
    v_mfma_f32_16x16x32_bf16 v[80:83], v[136:139], v[208:211], v[80:83]
    v_mfma_f32_16x16x32_bf16 v[84:87], v[136:139], v[212:215], v[84:87]
    v_mfma_f32_16x16x32_bf16 v[88:91], v[136:139], v[216:219], v[88:91]
    v_mfma_f32_16x16x32_bf16 v[92:95], v[136:139], v[220:223], v[92:95]
    s_waitcnt lgkmcnt(0)
    v_mfma_f32_16x16x32_bf16 v[96:99], v[160:163], v[132:135], v[96:99]
    v_mfma_f32_16x16x32_bf16 v[100:103], v[164:167], v[132:135], v[100:103]
    v_cvt_pk_bf16_f32 v16, v64, v65
    v_cvt_pk_bf16_f32 v17, v66, v67
    v_mfma_f32_16x16x32_bf16 v[104:107], v[168:171], v[132:135], v[104:107]
    v_cvt_pk_bf16_f32 v18, v68, v69
    v_cvt_pk_bf16_f32 v19, v70, v71
    v_mfma_f32_16x16x32_bf16 v[108:111], v[172:175], v[132:135], v[108:111]
    v_cvt_pk_bf16_f32 v20, v72, v73
    v_cvt_pk_bf16_f32 v21, v74, v75
    v_mfma_f32_16x16x32_bf16 v[112:115], v[176:179], v[132:135], v[112:115]
    v_cvt_pk_bf16_f32 v22, v76, v77
    v_cvt_pk_bf16_f32 v23, v78, v79
    v_mfma_f32_16x16x32_bf16 v[116:119], v[180:183], v[132:135], v[116:119]
    v_permlane16_swap_b32 v16, v18
    v_permlane16_swap_b32 v17, v19
    v_mfma_f32_16x16x32_bf16 v[120:123], v[184:187], v[132:135], v[120:123]
    v_cvt_pk_bf16_f32 v24, v80, v81
    v_cvt_pk_bf16_f32 v25, v82, v83
    v_mfma_f32_16x16x32_bf16 v[124:127], v[188:191], v[132:135], v[124:127]
    v_cvt_pk_bf16_f32 v26, v84, v85
    v_cvt_pk_bf16_f32 v27, v86, v87
    v_mfma_f32_16x16x32_bf16 v[96:99], v[192:195], v[140:143], v[96:99]
    v_permlane16_swap_b32 v20, v22
    v_permlane16_swap_b32 v21, v23
    v_mfma_f32_16x16x32_bf16 v[100:103], v[196:199], v[140:143], v[100:103]
    v_mfma_f32_32x32x16_bf16 v[160:175], v[144:147], v[16:19], 0
    v_cvt_pk_bf16_f32 v28, v88, v89
    v_cvt_pk_bf16_f32 v29, v90, v91
    v_mfma_f32_16x16x32_bf16 v[104:107], v[200:203], v[140:143], v[104:107]
    v_cvt_pk_bf16_f32 v30, v92, v93
    v_cvt_pk_bf16_f32 v31, v94, v95
    v_mfma_f32_16x16x32_bf16 v[108:111], v[204:207], v[140:143], v[108:111]
    v_permlane16_swap_b32 v24, v26
    v_permlane16_swap_b32 v25, v27
    v_mfma_f32_16x16x32_bf16 v[112:115], v[208:211], v[140:143], v[112:115]
    v_mfma_f32_32x32x16_bf16 v[176:191], v[144:147], v[20:23], 0
    v_permlane16_swap_b32 v28, v30
    v_permlane16_swap_b32 v29, v31
    v_mfma_f32_16x16x32_bf16 v[116:119], v[212:215], v[140:143], v[116:119]
    v_mfma_f32_16x16x32_bf16 v[120:123], v[216:219], v[140:143], v[120:123]
    v_mfma_f32_16x16x32_bf16 v[124:127], v[220:223], v[140:143], v[124:127]
    v_mfma_f32_32x32x16_bf16 v[192:207], v[144:147], v[24:27], 0
    v_mfma_f32_32x32x16_bf16 v[208:223], v[144:147], v[28:31], 0
    v_max3_f32 v152, v160, v161, v162
    s_nop 3
    v_max3_f32 v156, v176, v177, v178
    v_max3_f32 v153, v163, v164, v165
    v_max3_f32 v157, v179, v180, v181
    v_max3_f32 v152, v152, v166, v167
    v_max3_f32 v156, v156, v182, v183
    v_max3_f32 v153, v153, v168, v169
    v_max3_f32 v157, v157, v184, v185
    v_max3_f32 v152, v152, v170, v171
    v_max3_f32 v156, v156, v186, v187
    v_max3_f32 v153, v153, v172, v173
    v_max3_f32 v157, v157, v188, v189
    v_max3_f32 v152, v152, v174, v175
    v_max3_f32 v156, v156, v190, v191
    v_max_f32 v152, v152, v153
    v_max_f32 v156, v156, v157
    v_mul_f32 v152, s56, v152
    v_mul_f32 v156, s56, v156
    v_cvt_pk_bf16_f32 v32, v96, v97
    v_cvt_pk_bf16_f32 v33, v98, v99
    v_cvt_pk_bf16_f32 v34, v100, v101
    v_cvt_pk_bf16_f32 v35, v102, v103
    v_cvt_pk_bf16_f32 v36, v104, v105
    v_cvt_pk_bf16_f32 v37, v106, v107
    v_cvt_pk_bf16_f32 v38, v108, v109
    v_cvt_pk_bf16_f32 v39, v110, v111
    v_cvt_pk_bf16_f32 v40, v112, v113
    v_cvt_pk_bf16_f32 v41, v114, v115
    v_cvt_pk_bf16_f32 v42, v116, v117
    v_cvt_pk_bf16_f32 v43, v118, v119
    v_cvt_pk_bf16_f32 v44, v120, v121
    v_cvt_pk_bf16_f32 v45, v122, v123
    v_cvt_pk_bf16_f32 v46, v124, v125
    v_cvt_pk_bf16_f32 v47, v126, v127
    v_mov_b32 v113, v149
    v_mov_b32 v115, v149
    v_mov_b32 v117, v149
    v_mov_b32 v119, v149
    v_mov_b32 v121, v149
    v_pk_fma_f32 v[160:161], v[160:161], s[54:55], v[152:153] op_sel_hi:[1,1,0]
    v_pk_fma_f32 v[176:177], v[176:177], s[54:55], v[156:157] op_sel_hi:[1,1,0]
    v_pk_fma_f32 v[162:163], v[162:163], s[54:55], v[152:153] op_sel_hi:[1,1,0]
    v_pk_fma_f32 v[178:179], v[178:179], s[54:55], v[156:157] op_sel_hi:[1,1,0]
    v_pk_fma_f32 v[164:165], v[164:165], s[54:55], v[152:153] op_sel_hi:[1,1,0]
    v_pk_fma_f32 v[180:181], v[180:181], s[54:55], v[156:157] op_sel_hi:[1,1,0]
    v_pk_fma_f32 v[166:167], v[166:167], s[54:55], v[152:153] op_sel_hi:[1,1,0]
    v_pk_fma_f32 v[182:183], v[182:183], s[54:55], v[156:157] op_sel_hi:[1,1,0]
    v_pk_fma_f32 v[168:169], v[168:169], s[54:55], v[152:153] op_sel_hi:[1,1,0]
    v_pk_fma_f32 v[184:185], v[184:185], s[54:55], v[156:157] op_sel_hi:[1,1,0]
    v_pk_fma_f32 v[170:171], v[170:171], s[54:55], v[152:153] op_sel_hi:[1,1,0]
    v_pk_fma_f32 v[186:187], v[186:187], s[54:55], v[156:157] op_sel_hi:[1,1,0]
    v_pk_fma_f32 v[172:173], v[172:173], s[54:55], v[152:153] op_sel_hi:[1,1,0]
    v_pk_fma_f32 v[188:189], v[188:189], s[54:55], v[156:157] op_sel_hi:[1,1,0]
    v_pk_fma_f32 v[174:175], v[174:175], s[54:55], v[152:153] op_sel_hi:[1,1,0]
    v_pk_fma_f32 v[190:191], v[190:191], s[54:55], v[156:157] op_sel_hi:[1,1,0]
    v_exp_f32 v160, v160
    v_exp_f32 v176, v176
    v_exp_f32 v161, v161
    v_exp_f32 v177, v177
    v_exp_f32 v162, v162
    v_exp_f32 v178, v178
    v_exp_f32 v163, v163
    v_exp_f32 v179, v179
    v_exp_f32 v164, v164
    v_exp_f32 v180, v180
    v_exp_f32 v165, v165
    v_exp_f32 v181, v181
    v_exp_f32 v166, v166
    v_exp_f32 v182, v182
    v_exp_f32 v167, v167
    v_exp_f32 v183, v183
    v_exp_f32 v168, v168
    v_exp_f32 v184, v184
    v_exp_f32 v169, v169
    v_exp_f32 v185, v185
    v_exp_f32 v170, v170
    v_exp_f32 v186, v186
    v_exp_f32 v171, v171
    v_exp_f32 v187, v187
    v_exp_f32 v172, v172
    v_exp_f32 v188, v188
    v_exp_f32 v173, v173
    v_exp_f32 v189, v189
    v_exp_f32 v174, v174
    v_exp_f32 v190, v190
    v_exp_f32 v175, v175
    v_exp_f32 v191, v191
    v_pk_add_f32 v[152:153], v[160:161], v[162:163]
    v_pk_add_f32 v[156:157], v[176:177], v[178:179]
    v_pk_add_f32 v[154:155], v[164:165], v[166:167]
    v_pk_add_f32 v[158:159], v[180:181], v[182:183]
    v_pk_add_f32 v[152:153], v[152:153], v[168:169]
    v_pk_add_f32 v[156:157], v[156:157], v[184:185]
    v_pk_add_f32 v[154:155], v[154:155], v[170:171]
    v_pk_add_f32 v[158:159], v[158:159], v[186:187]
    v_pk_add_f32 v[152:153], v[152:153], v[172:173]
    v_pk_add_f32 v[156:157], v[156:157], v[188:189]
    v_pk_add_f32 v[154:155], v[154:155], v[174:175]
    v_pk_add_f32 v[158:159], v[158:159], v[190:191]
    v_pk_add_f32 v[152:153], v[152:153], v[154:155]
    v_pk_add_f32 v[156:157], v[156:157], v[158:159]
    v_add_f32 v152, v152, v153
    v_add_f32 v156, v156, v157
    v_rcp_f32 v152, v152
    v_rcp_f32 v156, v156
    v_pk_mul_f32 v[160:161], v[160:161], v[152:153] op_sel_hi:[1,0]
    v_pk_mul_f32 v[176:177], v[176:177], v[156:157] op_sel_hi:[1,0]
    v_pk_mul_f32 v[162:163], v[162:163], v[152:153] op_sel_hi:[1,0]
    v_pk_mul_f32 v[178:179], v[178:179], v[156:157] op_sel_hi:[1,0]
    v_pk_mul_f32 v[164:165], v[164:165], v[152:153] op_sel_hi:[1,0]
    v_pk_mul_f32 v[180:181], v[180:181], v[156:157] op_sel_hi:[1,0]
    v_pk_mul_f32 v[166:167], v[166:167], v[152:153] op_sel_hi:[1,0]
    v_pk_mul_f32 v[182:183], v[182:183], v[156:157] op_sel_hi:[1,0]
    v_pk_mul_f32 v[168:169], v[168:169], v[152:153] op_sel_hi:[1,0]
    v_pk_mul_f32 v[184:185], v[184:185], v[156:157] op_sel_hi:[1,0]
    v_pk_mul_f32 v[170:171], v[170:171], v[152:153] op_sel_hi:[1,0]
    v_pk_mul_f32 v[186:187], v[186:187], v[156:157] op_sel_hi:[1,0]
    v_pk_mul_f32 v[172:173], v[172:173], v[152:153] op_sel_hi:[1,0]
    v_pk_mul_f32 v[188:189], v[188:189], v[156:157] op_sel_hi:[1,0]
    v_pk_mul_f32 v[174:175], v[174:175], v[152:153] op_sel_hi:[1,0]
    v_pk_mul_f32 v[190:191], v[190:191], v[156:157] op_sel_hi:[1,0]
    v_cvt_pk_bf16_f32 v64, v160, v161
    v_cvt_pk_bf16_f32 v72, v176, v177
    v_cvt_pk_bf16_f32 v65, v162, v163
    v_cvt_pk_bf16_f32 v73, v178, v179
    v_cvt_pk_bf16_f32 v66, v164, v165
    v_cvt_pk_bf16_f32 v74, v180, v181
    v_cvt_pk_bf16_f32 v67, v166, v167
    v_cvt_pk_bf16_f32 v75, v182, v183
    v_cvt_pk_bf16_f32 v68, v168, v169
    v_cvt_pk_bf16_f32 v76, v184, v185
    v_cvt_pk_bf16_f32 v69, v170, v171
    v_cvt_pk_bf16_f32 v77, v186, v187
    v_cvt_pk_bf16_f32 v70, v172, v173
    v_cvt_pk_bf16_f32 v78, v188, v189
    v_cvt_pk_bf16_f32 v71, v174, v175
    v_cvt_pk_bf16_f32 v79, v190, v191
    ds_write_b128 v231, v[64:67] offset:0
    ds_write_b128 v232, v[68:71] offset:0
    ds_write_b128 v231, v[72:75] offset:2048
    ds_write_b128 v232, v[76:79] offset:2048
    v_max3_f32 v152, v192, v193, v194
    v_max3_f32 v156, v208, v209, v210
    v_max3_f32 v153, v195, v196, v197
    v_max3_f32 v157, v211, v212, v213
    v_max3_f32 v152, v152, v198, v199
    v_max3_f32 v156, v156, v214, v215
    v_max3_f32 v153, v153, v200, v201
    v_max3_f32 v157, v157, v216, v217
    v_max3_f32 v152, v152, v202, v203
    v_max3_f32 v156, v156, v218, v219
    v_max3_f32 v153, v153, v204, v205
    v_max3_f32 v157, v157, v220, v221
    v_max3_f32 v152, v152, v206, v207
    v_max3_f32 v156, v156, v222, v223
    v_max_f32 v152, v152, v153
    v_max_f32 v156, v156, v157
    v_mul_f32 v152, s56, v152
    v_mul_f32 v156, s56, v156
    ds_read_b64_tr_b16 v[128:129], v233 offset:0
    ds_read_b64_tr_b16 v[130:131], v233 offset:1024
    ds_read_b64_tr_b16 v[132:133], v234 offset:0
    ds_read_b64_tr_b16 v[134:135], v234 offset:1024
    ds_read_b64_tr_b16 v[136:137], v233 offset:2048
    ds_read_b64_tr_b16 v[138:139], v233 offset:3072
    ds_read_b64_tr_b16 v[140:141], v234 offset:2048
    ds_read_b64_tr_b16 v[142:143], v234 offset:3072
    v_pk_fma_f32 v[192:193], v[192:193], s[54:55], v[152:153] op_sel_hi:[1,1,0]
    v_pk_fma_f32 v[208:209], v[208:209], s[54:55], v[156:157] op_sel_hi:[1,1,0]
    v_pk_fma_f32 v[194:195], v[194:195], s[54:55], v[152:153] op_sel_hi:[1,1,0]
    v_pk_fma_f32 v[210:211], v[210:211], s[54:55], v[156:157] op_sel_hi:[1,1,0]
    v_pk_fma_f32 v[196:197], v[196:197], s[54:55], v[152:153] op_sel_hi:[1,1,0]
    v_pk_fma_f32 v[212:213], v[212:213], s[54:55], v[156:157] op_sel_hi:[1,1,0]
    v_pk_fma_f32 v[198:199], v[198:199], s[54:55], v[152:153] op_sel_hi:[1,1,0]
    v_pk_fma_f32 v[214:215], v[214:215], s[54:55], v[156:157] op_sel_hi:[1,1,0]
    v_pk_fma_f32 v[200:201], v[200:201], s[54:55], v[152:153] op_sel_hi:[1,1,0]
    v_pk_fma_f32 v[216:217], v[216:217], s[54:55], v[156:157] op_sel_hi:[1,1,0]
    v_pk_fma_f32 v[202:203], v[202:203], s[54:55], v[152:153] op_sel_hi:[1,1,0]
    v_pk_fma_f32 v[218:219], v[218:219], s[54:55], v[156:157] op_sel_hi:[1,1,0]
    v_pk_fma_f32 v[204:205], v[204:205], s[54:55], v[152:153] op_sel_hi:[1,1,0]
    v_pk_fma_f32 v[220:221], v[220:221], s[54:55], v[156:157] op_sel_hi:[1,1,0]
    v_pk_fma_f32 v[206:207], v[206:207], s[54:55], v[152:153] op_sel_hi:[1,1,0]
    v_pk_fma_f32 v[222:223], v[222:223], s[54:55], v[156:157] op_sel_hi:[1,1,0]
    v_exp_f32 v192, v192
    v_exp_f32 v208, v208
    v_exp_f32 v193, v193
    v_exp_f32 v209, v209
    v_exp_f32 v194, v194
    v_exp_f32 v210, v210
    v_exp_f32 v195, v195
    s_waitcnt lgkmcnt(6)
    v_mfma_f32_16x16x32_bf16 v[96:99], v[128:131], v[32:35], 0
    v_exp_f32 v211, v211
    v_exp_f32 v196, v196
    v_exp_f32 v212, v212
    v_mfma_f32_16x16x32_bf16 v[104:107], v[128:131], v[248:251], 0
    v_exp_f32 v197, v197
    v_exp_f32 v213, v213
    v_exp_f32 v198, v198
    s_waitcnt lgkmcnt(4)
    v_mfma_f32_16x16x32_bf16 v[100:103], v[132:135], v[32:35], 0
    v_exp_f32 v214, v214
    v_exp_f32 v199, v199
    v_exp_f32 v215, v215
    v_mfma_f32_16x16x32_bf16 v[108:111], v[132:135], v[248:251], 0
    v_exp_f32 v200, v200
    v_exp_f32 v216, v216
    v_exp_f32 v201, v201
    s_waitcnt lgkmcnt(2)
    v_mfma_f32_16x16x32_bf16 v[96:99], v[136:139], v[36:39], v[96:99]
    v_exp_f32 v217, v217
    v_exp_f32 v202, v202
    v_exp_f32 v218, v218
    v_mfma_f32_16x16x32_bf16 v[104:107], v[136:139], v[248:251], v[104:107]
    v_exp_f32 v203, v203
    v_exp_f32 v219, v219
    v_exp_f32 v204, v204
    s_waitcnt lgkmcnt(0)
    v_mfma_f32_16x16x32_bf16 v[100:103], v[140:143], v[36:39], v[100:103]
    v_exp_f32 v220, v220
    v_exp_f32 v205, v205
    v_exp_f32 v221, v221
    v_mfma_f32_16x16x32_bf16 v[108:111], v[140:143], v[248:251], v[108:111]
    v_exp_f32 v206, v206
    v_exp_f32 v222, v222
    v_exp_f32 v207, v207
    v_exp_f32 v223, v223
    v_pk_add_f32 v[152:153], v[192:193], v[194:195]
    v_pk_add_f32 v[156:157], v[208:209], v[210:211]
    v_pk_add_f32 v[154:155], v[196:197], v[198:199]
    v_pk_add_f32 v[158:159], v[212:213], v[214:215]
    v_pk_add_f32 v[152:153], v[152:153], v[200:201]
    v_pk_add_f32 v[156:157], v[156:157], v[216:217]
    v_pk_add_f32 v[154:155], v[154:155], v[202:203]
    v_pk_add_f32 v[158:159], v[158:159], v[218:219]
    v_pk_add_f32 v[152:153], v[152:153], v[204:205]
    v_pk_add_f32 v[156:157], v[156:157], v[220:221]
    v_pk_add_f32 v[154:155], v[154:155], v[206:207]
    v_pk_add_f32 v[158:159], v[158:159], v[222:223]
    v_pk_add_f32 v[152:153], v[152:153], v[154:155]
    v_pk_add_f32 v[156:157], v[156:157], v[158:159]
    v_add_f32 v152, v152, v153
    v_add_f32 v156, v156, v157
    v_rcp_f32 v152, v152
    v_rcp_f32 v156, v156
    v_pk_mul_f32 v[192:193], v[192:193], v[152:153] op_sel_hi:[1,0]
    v_pk_mul_f32 v[194:195], v[194:195], v[152:153] op_sel_hi:[1,0]
    v_pk_mul_f32 v[196:197], v[196:197], v[152:153] op_sel_hi:[1,0]
    v_pk_mul_f32 v[198:199], v[198:199], v[152:153] op_sel_hi:[1,0]
    v_pk_mul_f32 v[200:201], v[200:201], v[152:153] op_sel_hi:[1,0]
    v_pk_mul_f32 v[202:203], v[202:203], v[152:153] op_sel_hi:[1,0]
    v_pk_mul_f32 v[204:205], v[204:205], v[152:153] op_sel_hi:[1,0]
    v_pk_mul_f32 v[206:207], v[206:207], v[152:153] op_sel_hi:[1,0]
    v_cvt_pk_bf16_f32 v80, v192, v193
    v_cvt_pk_bf16_f32 v81, v194, v195
    v_cvt_pk_bf16_f32 v82, v196, v197
    v_cvt_pk_bf16_f32 v83, v198, v199
    v_cvt_pk_bf16_f32 v84, v200, v201
    v_cvt_pk_bf16_f32 v85, v202, v203
    v_cvt_pk_bf16_f32 v86, v204, v205
    v_cvt_pk_bf16_f32 v87, v206, v207
    ds_write_b128 v231, v[80:83] offset:0
    ds_write_b128 v232, v[84:87] offset:0
    ds_read_b64_tr_b16 v[48:49], v233 offset:0
    ds_read_b64_tr_b16 v[50:51], v233 offset:1024
    ds_read_b64_tr_b16 v[52:53], v234 offset:0
    ds_read_b64_tr_b16 v[54:55], v234 offset:1024
    v_pk_mul_f32 v[208:209], v[208:209], v[156:157] op_sel_hi:[1,0]
    v_pk_mul_f32 v[210:211], v[210:211], v[156:157] op_sel_hi:[1,0]
    v_pk_mul_f32 v[212:213], v[212:213], v[156:157] op_sel_hi:[1,0]
    v_pk_mul_f32 v[214:215], v[214:215], v[156:157] op_sel_hi:[1,0]
    v_pk_mul_f32 v[216:217], v[216:217], v[156:157] op_sel_hi:[1,0]
    v_pk_mul_f32 v[218:219], v[218:219], v[156:157] op_sel_hi:[1,0]
    v_pk_mul_f32 v[220:221], v[220:221], v[156:157] op_sel_hi:[1,0]
    v_pk_mul_f32 v[222:223], v[222:223], v[156:157] op_sel_hi:[1,0]
    s_barrier
    s_setprio 3
    v_cvt_pk_bf16_f32 v88, v208, v209
    v_cvt_pk_bf16_f32 v89, v210, v211
    v_cvt_pk_bf16_f32 v90, v212, v213
    v_cvt_pk_bf16_f32 v91, v214, v215
    v_cvt_pk_bf16_f32 v92, v216, v217
    v_cvt_pk_bf16_f32 v93, v218, v219
    v_cvt_pk_bf16_f32 v94, v220, v221
    v_cvt_pk_bf16_f32 v95, v222, v223
    ds_write_b128 v231, v[88:91] offset:2048
    ds_write_b128 v232, v[92:95] offset:2048
    ds_read_b64_tr_b16 v[56:57], v233 offset:2048
    ds_read_b64_tr_b16 v[58:59], v233 offset:3072
    ds_read_b64_tr_b16 v[60:61], v234 offset:2048
    ds_read_b64_tr_b16 v[62:63], v234 offset:3072
    s_waitcnt lgkmcnt(8)
    v_mfma_f32_16x16x32_bf16 v[96:99], v[48:51], v[40:43], v[96:99]
    v_mfma_f32_16x16x32_bf16 v[104:107], v[48:51], v[248:251], v[104:107]
    s_waitcnt lgkmcnt(6)
    v_mfma_f32_16x16x32_bf16 v[100:103], v[52:55], v[40:43], v[100:103]
    v_mfma_f32_16x16x32_bf16 v[108:111], v[52:55], v[248:251], v[108:111]
    s_waitcnt lgkmcnt(2)
    v_mfma_f32_16x16x32_bf16 v[96:99], v[56:59], v[44:47], v[96:99]
    v_mfma_f32_16x16x32_bf16 v[104:107], v[56:59], v[248:251], v[104:107]
    s_waitcnt lgkmcnt(0)
    v_mfma_f32_16x16x32_bf16 v[100:103], v[60:63], v[44:47], v[100:103]
    v_mfma_f32_16x16x32_bf16 v[108:111], v[60:63], v[248:251], v[108:111]
    s_nop 3
    v_cvt_pk_bf16_f32 v112, v96, v97
    buffer_store_dwordx2 v[112:113], v229, s[28:31], s59 offen offset:0 sc1
    v_cvt_pk_bf16_f32 v114, v98, v99
    buffer_store_dwordx2 v[114:115], v229, s[28:31], s59 offen offset:2048 sc1
    v_cvt_pk_bf16_f32 v116, v100, v101
    buffer_store_dwordx2 v[116:117], v229, s[28:31], s60 offen offset:0 sc1
    v_cvt_pk_bf16_f32 v118, v102, v103
    buffer_store_dwordx2 v[118:119], v229, s[28:31], s60 offen offset:2048 sc1
    v_cvt_pk_bf16_f32 v122, v104, v105
    v_cvt_pk_bf16_f32 v123, v106, v107
    v_cvt_pk_bf16_f32 v124, v108, v109
    v_cvt_pk_bf16_f32 v125, v110, v111
    v_bfi_b32 v122, v245, v123, v122
    v_bfi_b32 v124, v245, v125, v124
    v_bfi_b32 v120, v246, v124, v122
    buffer_store_dwordx2 v[120:121], v230, s[28:31], s47 offen offset:2048 sc1
    s_add_u32 s8, s63, 0
    s_and_b32 s8, s8, 63
    s_lshl_b32 s57, s8, 10
    s_add_u32 m0, s57, 32768
    s_add_u32 s8, s8, s35
    s_and_b32 s8, s8, 63
    s_lshl_b32 s8, s8, 13
    s_add_u32 s8, s8, s46
    buffer_load_dwordx4 v240, s[20:23], s8 offen lds
    s_add_u32 s8, s63, 4
    s_and_b32 s8, s8, 63
    s_lshl_b32 s57, s8, 10
    s_add_u32 m0, s57, 32768
    s_add_u32 s8, s8, s35
    s_and_b32 s8, s8, 63
    s_lshl_b32 s8, s8, 13
    s_add_u32 s8, s8, s46
    buffer_load_dwordx4 v240, s[20:23], s8 offen lds
    s_add_u32 s8, s63, 8
    s_and_b32 s8, s8, 63
    s_lshl_b32 s57, s8, 10
    s_add_u32 m0, s57, 32768
    s_add_u32 s8, s8, s35
    s_and_b32 s8, s8, 63
    s_lshl_b32 s8, s8, 13
    s_add_u32 s8, s8, s46
    buffer_load_dwordx4 v240, s[20:23], s8 offen lds
    s_add_u32 s8, s63, 12
    s_and_b32 s8, s8, 63
    s_lshl_b32 s57, s8, 10
    s_add_u32 m0, s57, 32768
    s_add_u32 s8, s8, s35
    s_and_b32 s8, s8, 63
    s_lshl_b32 s8, s8, 13
    s_add_u32 s8, s8, s46
    buffer_load_dwordx4 v240, s[20:23], s8 offen lds
    s_add_u32 s8, s63, 16
    s_and_b32 s8, s8, 63
    s_lshl_b32 s57, s8, 10
    s_add_u32 m0, s57, 32768
    s_add_u32 s8, s8, s35
    s_and_b32 s8, s8, 63
    s_lshl_b32 s8, s8, 13
    s_add_u32 s8, s8, s46
    buffer_load_dwordx4 v240, s[20:23], s8 offen lds
    s_add_u32 s8, s63, 20
    s_and_b32 s8, s8, 63
    s_lshl_b32 s57, s8, 10
    s_add_u32 m0, s57, 32768
    s_add_u32 s8, s8, s35
    s_and_b32 s8, s8, 63
    s_lshl_b32 s8, s8, 13
    s_add_u32 s8, s8, s46
    buffer_load_dwordx4 v240, s[20:23], s8 offen lds
    s_setprio 3
    s_mov_b32 s68, 0
K_rs:
    buffer_load_dwordx2 v[48:49], v252, s[28:31], s58 offen offset:0 sc1
    buffer_load_dwordx2 v[50:51], v252, s[28:31], s58 offen offset:512 sc1
    buffer_load_dwordx2 v[52:53], v252, s[28:31], s58 offen offset:1024 sc1
    buffer_load_dwordx2 v[54:55], v252, s[28:31], s58 offen offset:1536 sc1
    s_add_u32 s68, s68, 1
    s_waitcnt vmcnt(0)
    v_min3_u32 v10, v49, v51, v149
    v_max3_u32 v11, v49, v51, v149
    v_min3_u32 v10, v10, v53, v55
    v_max3_u32 v11, v11, v53, v55
    v_cmp_ne_u32 vcc, v10, v11
    s_cmp_ge_u32 s68, 16384
    s_cbranch_scc1 K_rsok
    s_cbranch_vccnz K_rs
K_rsok:
    v_lshlrev_b32 v32, 16, v48
    v_and_b32 v33, 0xffff0000, v48
    v_lshlrev_b32 v34, 16, v50
    v_and_b32 v35, 0xffff0000, v50
    v_lshlrev_b32 v36, 16, v52
    v_and_b32 v37, 0xffff0000, v52
    v_lshlrev_b32 v38, 16, v54
    v_and_b32 v39, 0xffff0000, v54
    v_add_f32 v32, v32, v34
    v_add_f32 v36, v36, v38
    v_add_f32 v33, v33, v35
    v_add_f32 v37, v37, v39
    v_add_f32 v32, v32, v36
    v_add_f32 v33, v33, v37
    v_mov_b32 v34, v32
    v_mov_b32 v35, v33
    s_nop 0
    v_permlane16_swap_b32 v32, v34
    v_permlane16_swap_b32 v33, v35
    v_add_f32 v32, v32, v34
    v_add_f32 v33, v33, v35
    v_mov_b32 v34, v32
    v_mov_b32 v35, v33
    s_nop 0
    v_permlane32_swap_b32 v32, v34
    v_permlane32_swap_b32 v33, v35
    v_add_f32 v32, v32, v34
    v_add_f32 v33, v33, v35
    v_cvt_pk_bf16_f32 v120, v32, v33
    buffer_store_dwordx2 v[120:121], v253, s[28:31], s47 offen sc1
    s_mov_b32 s65, 0
    buffer_load_dwordx2 v[56:57], v252, s[28:31], s62 offen offset:2048 sc1
    buffer_load_dwordx2 v[58:59], v252, s[28:31], s62 offen offset:2560 sc1
    buffer_load_dwordx2 v[60:61], v252, s[28:31], s62 offen offset:3072 sc1
    buffer_load_dwordx2 v[62:63], v252, s[28:31], s62 offen offset:3584 sc1
    s_add_u32 s8, s63, 24
    s_and_b32 s8, s8, 63
    s_lshl_b32 s57, s8, 10
    s_add_u32 m0, s57, 32768
    s_add_u32 s8, s8, s35
    s_and_b32 s8, s8, 63
    s_lshl_b32 s8, s8, 13
    s_add_u32 s8, s8, s46
    buffer_load_dwordx4 v240, s[20:23], s8 offen lds
    s_add_u32 s8, s63, 28
    s_and_b32 s8, s8, 63
    s_lshl_b32 s57, s8, 10
    s_add_u32 m0, s57, 32768
    s_add_u32 s8, s8, s35
    s_and_b32 s8, s8, 63
    s_lshl_b32 s8, s8, 13
    s_add_u32 s8, s8, s46
    buffer_load_dwordx4 v240, s[20:23], s8 offen lds
    s_add_u32 s8, s63, 32
    s_and_b32 s8, s8, 63
    s_lshl_b32 s57, s8, 10
    s_add_u32 m0, s57, 32768
    s_add_u32 s8, s8, s35
    s_and_b32 s8, s8, 63
    s_lshl_b32 s8, s8, 13
    s_add_u32 s8, s8, s46
    buffer_load_dwordx4 v240, s[20:23], s8 offen lds
    s_add_u32 s8, s63, 36
    s_and_b32 s8, s8, 63
    s_lshl_b32 s57, s8, 10
    s_add_u32 m0, s57, 32768
    s_add_u32 s8, s8, s35
    s_and_b32 s8, s8, 63
    s_lshl_b32 s8, s8, 13
    s_add_u32 s8, s8, s46
    buffer_load_dwordx4 v240, s[20:23], s8 offen lds
    s_add_u32 s8, s63, 40
    s_and_b32 s8, s8, 63
    s_lshl_b32 s57, s8, 10
    s_add_u32 m0, s57, 32768
    s_add_u32 s8, s8, s35
    s_and_b32 s8, s8, 63
    s_lshl_b32 s8, s8, 13
    s_add_u32 s8, s8, s46
    buffer_load_dwordx4 v240, s[20:23], s8 offen lds
    s_add_u32 s8, s63, 44
    s_and_b32 s8, s8, 63
    s_lshl_b32 s57, s8, 10
    s_add_u32 m0, s57, 32768
    s_add_u32 s8, s8, s35
    s_and_b32 s8, s8, 63
    s_lshl_b32 s8, s8, 13
    s_add_u32 s8, s8, s46
    buffer_load_dwordx4 v240, s[20:23], s8 offen lds
    s_add_u32 s8, s63, 48
    s_and_b32 s8, s8, 63
    s_lshl_b32 s57, s8, 10
    s_add_u32 m0, s57, 32768
    s_add_u32 s8, s8, s35
    s_and_b32 s8, s8, 63
    s_lshl_b32 s8, s8, 13
    s_add_u32 s8, s8, s46
    buffer_load_dwordx4 v240, s[20:23], s8 offen lds
    s_add_u32 s8, s63, 52
    s_and_b32 s8, s8, 63
    s_lshl_b32 s57, s8, 10
    s_add_u32 m0, s57, 32768
    s_add_u32 s8, s8, s35
    s_and_b32 s8, s8, 63
    s_lshl_b32 s8, s8, 13
    s_add_u32 s8, s8, s46
    buffer_load_dwordx4 v240, s[20:23], s8 offen lds
    s_add_u32 s8, s63, 56
    s_and_b32 s8, s8, 63
    s_lshl_b32 s57, s8, 10
    s_add_u32 m0, s57, 32768
    s_add_u32 s8, s8, s35
    s_and_b32 s8, s8, 63
    s_lshl_b32 s8, s8, 13
    s_add_u32 s8, s8, s46
    buffer_load_dwordx4 v240, s[20:23], s8 offen lds
    s_add_u32 s8, s63, 60
    s_and_b32 s8, s8, 63
    s_lshl_b32 s57, s8, 10
    s_add_u32 m0, s57, 32768
    s_add_u32 s8, s8, s35
    s_and_b32 s8, s8, 63
    s_lshl_b32 s8, s8, 13
    s_add_u32 s8, s8, s46
    buffer_load_dwordx4 v240, s[20:23], s8 offen lds
    s_waitcnt vmcnt(10)
    s_branch K_zc
K_z:
    buffer_load_dwordx2 v[56:57], v252, s[28:31], s62 offen offset:2048 sc1
    buffer_load_dwordx2 v[58:59], v252, s[28:31], s62 offen offset:2560 sc1
    buffer_load_dwordx2 v[60:61], v252, s[28:31], s62 offen offset:3072 sc1
    buffer_load_dwordx2 v[62:63], v252, s[28:31], s62 offen offset:3584 sc1
    s_add_u32 s65, s65, 1
    s_waitcnt vmcnt(0)
K_zc:
    v_min3_u32 v10, v57, v59, v149
    v_max3_u32 v11, v57, v59, v149
    v_min3_u32 v10, v10, v61, v63
    v_max3_u32 v11, v11, v61, v63
    v_cmp_ne_u32 vcc, v10, v11
    s_cmp_ge_u32 s65, 16384
    s_cbranch_scc1 K_zok
    s_cbranch_vccnz K_z
K_zok:
    v_lshlrev_b32 v32, 16, v56
    v_and_b32 v33, 0xffff0000, v56
    v_lshlrev_b32 v34, 16, v58
    v_and_b32 v35, 0xffff0000, v58
    v_lshlrev_b32 v36, 16, v60
    v_and_b32 v37, 0xffff0000, v60
    v_lshlrev_b32 v38, 16, v62
    v_and_b32 v39, 0xffff0000, v62
    v_add_f32 v32, v32, v34
    v_add_f32 v36, v36, v38
    v_add_f32 v33, v33, v35
    v_add_f32 v37, v37, v39
    v_add_f32 v32, v32, v36
    v_add_f32 v33, v33, v37
    v_mov_b32 v34, v32
    v_mov_b32 v35, v33
    s_nop 0
    v_permlane16_swap_b32 v32, v34
    v_permlane16_swap_b32 v33, v35
    v_add_f32 v32, v32, v34
    v_add_f32 v33, v33, v35
    v_mov_b32 v34, v32
    v_mov_b32 v35, v33
    s_nop 0
    v_permlane32_swap_b32 v32, v34
    v_permlane32_swap_b32 v33, v35
    v_add_f32 v32, v32, v34
    v_add_f32 v33, v33, v35
    v_cvt_pk_bf16_f32 v40, v32, v33
    ds_write2_b32 v239, v40, v40 offset0:0 offset1:16
    s_mov_b32 s65, 0
K_ag:
    buffer_load_dwordx2 v[24:25], v235, s[28:31], s62 offen offset:0 sc1
    buffer_load_dwordx2 v[26:27], v235, s[28:31], s62 offen offset:128 sc1
    buffer_load_dwordx2 v[28:29], v235, s[28:31], s62 offen offset:1024 sc1
    buffer_load_dwordx2 v[30:31], v235, s[28:31], s62 offen offset:1152 sc1
    s_add_u32 s65, s65, 1
    s_waitcnt vmcnt(0)
    v_min3_u32 v10, v25, v27, v149
    v_max3_u32 v11, v25, v27, v149
    v_min3_u32 v10, v10, v29, v31
    v_max3_u32 v11, v11, v29, v31
    v_cmp_ne_u32 vcc, v10, v11
    s_cmp_ge_u32 s65, 16384
    s_cbranch_scc1 K_agok
    s_cbranch_vccnz K_ag
K_agok:
    ds_write2_b32 v238, v24, v26 offset0:0 offset1:1
    ds_write2_b32 v238, v28, v30 offset0:128 offset1:129
    v_mov_b32 v117, v149
    s_setprio 0
    s_waitcnt lgkmcnt(0)
    s_barrier
    v_and_b32 v10, 7, v2
    v_lshlrev_b32 v11, 2, v9
    v_xor_b32 v11, v11, v10
    v_lshlrev_b32 v11, 4, v11
    v_lshl_add_u32 v11, v3, 7, v11
    v_add_u32 v231, s52, v11
    v_lshrrev_b32 v11, 3, v2
    v_xor_b32 v10, v10, v11
    v_lshlrev_b32 v10, 4, v10
    v_lshl_add_u32 v10, v11, 7, v10
    v_add_u32 v232, s52, v10
    s_add_u32 s8, s34, 0
    s_and_b32 s8, s8, 7
    s_lshl_b32 s8, s8, 12
    s_add_u32 s12, s8, s37
    s_add_u32 s8, s34, 1
    s_and_b32 s8, s8, 7
    s_lshl_b32 s8, s8, 12
    s_add_u32 s13, s8, s37
    s_add_u32 s8, s34, 2
    s_and_b32 s8, s8, 7
    s_lshl_b32 s8, s8, 12
    s_add_u32 s14, s8, s37
    s_add_u32 s8, s34, 3
    s_and_b32 s8, s8, 7
    s_lshl_b32 s8, s8, 12
    s_add_u32 s15, s8, s37
    s_add_u32 s8, s34, 4
    s_and_b32 s8, s8, 7
    s_lshl_b32 s8, s8, 12
    s_add_u32 s16, s8, s37
    s_add_u32 s8, s34, 5
    s_and_b32 s8, s8, 7
    s_lshl_b32 s8, s8, 12
    s_add_u32 s17, s8, s37
    s_add_u32 s8, s34, 6
    s_and_b32 s8, s8, 7
    s_lshl_b32 s8, s8, 12
    s_add_u32 s18, s8, s37
    s_add_u32 s8, s34, 7
    s_and_b32 s8, s8, 7
    s_lshl_b32 s8, s8, 12
    s_add_u32 s19, s8, s37
    s_mov_b32 s64, 0
    s_mov_b32 s65, 0
    ds_read_b64_tr_b16 v[128:129], v241 offset:0
    ds_read_b64_tr_b16 v[130:131], v241 offset:1024
    ds_read_b64_tr_b16 v[132:133], v242 offset:0
    ds_read_b64_tr_b16 v[134:135], v242 offset:1024
    ds_read_b64_tr_b16 v[136:137], v241 offset:2048
    ds_read_b64_tr_b16 v[138:139], v241 offset:3072
    ds_read_b64_tr_b16 v[140:141], v242 offset:2048
    ds_read_b64_tr_b16 v[142:143], v242 offset:3072
    ds_read_b64_tr_b16 v[144:145], v241 offset:4096
    ds_read_b64_tr_b16 v[146:147], v241 offset:5120
    ds_read_b64_tr_b16 v[148:149], v242 offset:4096
    ds_read_b64_tr_b16 v[150:151], v242 offset:5120
    ds_read_b64_tr_b16 v[152:153], v241 offset:6144
    ds_read_b64_tr_b16 v[154:155], v241 offset:7168
    ds_read_b64_tr_b16 v[156:157], v242 offset:6144
    ds_read_b64_tr_b16 v[158:159], v242 offset:7168
    v_add_u32 v13, s52, v228
    s_barrier
    ds_read_b128 v[48:51], v13 offset:0
    ds_read_b128 v[52:55], v13 offset:1024
    ds_read_b128 v[56:59], v13 offset:2048
    ds_read_b128 v[60:63], v13 offset:3072
    s_waitcnt lgkmcnt(3)
    v_mfma_f32_32x32x16_bf16 v[16:31], v[128:131], v[48:51], 0
    v_mfma_f32_32x32x16_bf16 v[32:47], v[132:135], v[48:51], 0
    s_waitcnt lgkmcnt(2)
    v_mfma_f32_32x32x16_bf16 v[16:31], v[136:139], v[52:55], v[16:31]
    v_mfma_f32_32x32x16_bf16 v[32:47], v[140:143], v[52:55], v[32:47]
    s_waitcnt lgkmcnt(1)
    v_mfma_f32_32x32x16_bf16 v[16:31], v[144:147], v[56:59], v[16:31]
    v_mfma_f32_32x32x16_bf16 v[32:47], v[148:151], v[56:59], v[32:47]
    s_waitcnt lgkmcnt(0)
    v_mfma_f32_32x32x16_bf16 v[16:31], v[152:155], v[60:63], v[16:31]
    v_mfma_f32_32x32x16_bf16 v[32:47], v[156:159], v[60:63], v[32:47]
    buffer_load_dword v14, v237, s[28:31], s38 offen sc1
    ds_read_b64_tr_b16 v[160:161], v241 offset:8192
    ds_read_b64_tr_b16 v[162:163], v241 offset:9216
    ds_read_b64_tr_b16 v[164:165], v242 offset:8192
    ds_read_b64_tr_b16 v[166:167], v242 offset:9216
    ds_read_b64_tr_b16 v[168:169], v241 offset:10240
    ds_read_b64_tr_b16 v[170:171], v241 offset:11264
    ds_read_b64_tr_b16 v[172:173], v242 offset:10240
    ds_read_b64_tr_b16 v[174:175], v242 offset:11264
    ds_read_b64_tr_b16 v[176:177], v241 offset:12288
    ds_read_b64_tr_b16 v[178:179], v241 offset:13312
    ds_read_b64_tr_b16 v[180:181], v242 offset:12288
    ds_read_b64_tr_b16 v[182:183], v242 offset:13312
    ds_read_b64_tr_b16 v[184:185], v241 offset:14336
    ds_read_b64_tr_b16 v[186:187], v241 offset:15360
    ds_read_b64_tr_b16 v[188:189], v242 offset:14336
    ds_read_b64_tr_b16 v[190:191], v242 offset:15360
    ds_read_b64_tr_b16 v[192:193], v241 offset:16384
    ds_read_b64_tr_b16 v[194:195], v241 offset:17408
    ds_read_b64_tr_b16 v[196:197], v242 offset:16384
    ds_read_b64_tr_b16 v[198:199], v242 offset:17408
    ds_read_b64_tr_b16 v[200:201], v241 offset:18432
    ds_read_b64_tr_b16 v[202:203], v241 offset:19456
    ds_read_b64_tr_b16 v[204:205], v242 offset:18432
    ds_read_b64_tr_b16 v[206:207], v242 offset:19456
    ds_read_b64_tr_b16 v[208:209], v241 offset:20480
    ds_read_b64_tr_b16 v[210:211], v241 offset:21504
    ds_read_b64_tr_b16 v[212:213], v242 offset:20480
    ds_read_b64_tr_b16 v[214:215], v242 offset:21504
    ds_read_b64_tr_b16 v[216:217], v241 offset:22528
    ds_read_b64_tr_b16 v[218:219], v241 offset:23552
    ds_read_b64_tr_b16 v[220:221], v242 offset:22528
    ds_read_b64_tr_b16 v[222:223], v242 offset:23552
    ds_read_b64_tr_b16 v[128:129], v241 offset:24576
    ds_read_b64_tr_b16 v[130:131], v241 offset:25600
    ds_read_b64_tr_b16 v[132:133], v242 offset:24576
    ds_read_b64_tr_b16 v[134:135], v242 offset:25600
    ds_read_b64_tr_b16 v[136:137], v241 offset:26624
    ds_read_b64_tr_b16 v[138:139], v241 offset:27648
    ds_read_b64_tr_b16 v[140:141], v242 offset:26624
    ds_read_b64_tr_b16 v[142:143], v242 offset:27648
    ds_read_b64_tr_b16 v[144:145], v241 offset:28672
    ds_read_b64_tr_b16 v[146:147], v241 offset:29696
    ds_read_b64_tr_b16 v[148:149], v242 offset:28672
    ds_read_b64_tr_b16 v[150:151], v242 offset:29696
    ds_read_b64_tr_b16 v[152:153], v241 offset:30720
    ds_read_b64_tr_b16 v[154:155], v241 offset:31744
    ds_read_b64_tr_b16 v[156:157], v242 offset:30720
    ds_read_b64_tr_b16 v[158:159], v242 offset:31744
    s_waitcnt vmcnt(0)
    v_cmp_eq_u32 vcc, v117, v14
    s_nop 1
    s_mov_b32 s64, vcc_lo
    s_bitcmp1_b32 s64, 1
    s_cbranch_scc0 K_n1
K_nr1:
    buffer_load_dwordx4 v[64:67], v228, s[28:31], s13 offen offset:0 sc1
    buffer_load_dwordx4 v[68:71], v228, s[28:31], s13 offen offset:1024 sc1
    buffer_load_dwordx4 v[72:75], v228, s[28:31], s13 offen offset:2048 sc1
    buffer_load_dwordx4 v[76:79], v228, s[28:31], s13 offen offset:3072 sc1
    s_bitcmp1_b32 s64, 2
    s_cbranch_scc0 K_n2
K_nr2:
    buffer_load_dwordx4 v[80:83], v228, s[28:31], s14 offen offset:0 sc1
    buffer_load_dwordx4 v[84:87], v228, s[28:31], s14 offen offset:1024 sc1
    buffer_load_dwordx4 v[88:91], v228, s[28:31], s14 offen offset:2048 sc1
    buffer_load_dwordx4 v[92:95], v228, s[28:31], s14 offen offset:3072 sc1
    s_bitcmp1_b32 s64, 3
    s_cbranch_scc0 K_n3
K_nr3:
    s_waitcnt vmcnt(7)
    s_waitcnt lgkmcnt(13)
    v_mfma_f32_32x32x16_bf16 v[16:31], v[160:163], v[64:67], v[16:31]
    buffer_load_dwordx4 v[96:99], v228, s[28:31], s15 offen offset:0 sc1
    v_mfma_f32_32x32x16_bf16 v[32:47], v[164:167], v[64:67], v[32:47]
    s_waitcnt vmcnt(7)
    v_mfma_f32_32x32x16_bf16 v[16:31], v[168:171], v[68:71], v[16:31]
    buffer_load_dwordx4 v[100:103], v228, s[28:31], s15 offen offset:1024 sc1
    v_mfma_f32_32x32x16_bf16 v[32:47], v[172:175], v[68:71], v[32:47]
    s_waitcnt vmcnt(7)
    v_mfma_f32_32x32x16_bf16 v[16:31], v[176:179], v[72:75], v[16:31]
    buffer_load_dwordx4 v[104:107], v228, s[28:31], s15 offen offset:2048 sc1
    v_mfma_f32_32x32x16_bf16 v[32:47], v[180:183], v[72:75], v[32:47]
    s_waitcnt vmcnt(7)
    v_mfma_f32_32x32x16_bf16 v[16:31], v[184:187], v[76:79], v[16:31]
    buffer_load_dwordx4 v[108:111], v228, s[28:31], s15 offen offset:3072 sc1
    v_mfma_f32_32x32x16_bf16 v[32:47], v[188:191], v[76:79], v[32:47]
    s_bitcmp1_b32 s64, 4
    s_cbranch_scc0 K_n4
K_nr4:
    s_waitcnt vmcnt(7)
    v_mfma_f32_32x32x16_bf16 v[16:31], v[192:195], v[80:83], v[16:31]
    ds_read_b64_tr_b16 v[160:161], v241 offset:32768
    ds_read_b64_tr_b16 v[162:163], v241 offset:33792
    buffer_load_dwordx4 v[48:51], v228, s[28:31], s16 offen offset:0 sc1
    v_mfma_f32_32x32x16_bf16 v[32:47], v[196:199], v[80:83], v[32:47]
    ds_read_b64_tr_b16 v[164:165], v242 offset:32768
    ds_read_b64_tr_b16 v[166:167], v242 offset:33792
    s_waitcnt vmcnt(7)
    v_mfma_f32_32x32x16_bf16 v[16:31], v[200:203], v[84:87], v[16:31]
    ds_read_b64_tr_b16 v[168:169], v241 offset:34816
    ds_read_b64_tr_b16 v[170:171], v241 offset:35840
    buffer_load_dwordx4 v[52:55], v228, s[28:31], s16 offen offset:1024 sc1
    v_mfma_f32_32x32x16_bf16 v[32:47], v[204:207], v[84:87], v[32:47]
    ds_read_b64_tr_b16 v[172:173], v242 offset:34816
    ds_read_b64_tr_b16 v[174:175], v242 offset:35840
    s_waitcnt vmcnt(7)
    v_mfma_f32_32x32x16_bf16 v[16:31], v[208:211], v[88:91], v[16:31]
    ds_read_b64_tr_b16 v[176:177], v241 offset:36864
    ds_read_b64_tr_b16 v[178:179], v241 offset:37888
    buffer_load_dwordx4 v[56:59], v228, s[28:31], s16 offen offset:2048 sc1
    v_mfma_f32_32x32x16_bf16 v[32:47], v[212:215], v[88:91], v[32:47]
    ds_read_b64_tr_b16 v[180:181], v242 offset:36864
    ds_read_b64_tr_b16 v[182:183], v242 offset:37888
    s_waitcnt vmcnt(7)
    v_mfma_f32_32x32x16_bf16 v[16:31], v[216:219], v[92:95], v[16:31]
    ds_read_b64_tr_b16 v[184:185], v241 offset:38912
    ds_read_b64_tr_b16 v[186:187], v241 offset:39936
    buffer_load_dwordx4 v[60:63], v228, s[28:31], s16 offen offset:3072 sc1
    v_mfma_f32_32x32x16_bf16 v[32:47], v[220:223], v[92:95], v[32:47]
    ds_read_b64_tr_b16 v[188:189], v242 offset:38912
    ds_read_b64_tr_b16 v[190:191], v242 offset:39936
    s_bitcmp1_b32 s64, 5
    s_cbranch_scc0 K_n5
K_nr5:
    s_waitcnt vmcnt(7)
    s_waitcnt lgkmcnt(13)
    v_mfma_f32_32x32x16_bf16 v[16:31], v[128:131], v[96:99], v[16:31]
    ds_read_b64_tr_b16 v[192:193], v241 offset:40960
    ds_read_b64_tr_b16 v[194:195], v241 offset:41984
    buffer_load_dwordx4 v[64:67], v228, s[28:31], s17 offen offset:0 sc1
    v_mfma_f32_32x32x16_bf16 v[32:47], v[132:135], v[96:99], v[32:47]
    ds_read_b64_tr_b16 v[196:197], v242 offset:40960
    ds_read_b64_tr_b16 v[198:199], v242 offset:41984
    s_waitcnt vmcnt(7)
    v_mfma_f32_32x32x16_bf16 v[16:31], v[136:139], v[100:103], v[16:31]
    ds_read_b64_tr_b16 v[200:201], v241 offset:43008
    ds_read_b64_tr_b16 v[202:203], v241 offset:44032
    buffer_load_dwordx4 v[68:71], v228, s[28:31], s17 offen offset:1024 sc1
    v_mfma_f32_32x32x16_bf16 v[32:47], v[140:143], v[100:103], v[32:47]
    ds_read_b64_tr_b16 v[204:205], v242 offset:43008
    ds_read_b64_tr_b16 v[206:207], v242 offset:44032
    s_waitcnt vmcnt(7)
    v_mfma_f32_32x32x16_bf16 v[16:31], v[144:147], v[104:107], v[16:31]
    ds_read_b64_tr_b16 v[208:209], v241 offset:45056
    ds_read_b64_tr_b16 v[210:211], v241 offset:46080
    buffer_load_dwordx4 v[72:75], v228, s[28:31], s17 offen offset:2048 sc1
    v_mfma_f32_32x32x16_bf16 v[32:47], v[148:151], v[104:107], v[32:47]
    ds_read_b64_tr_b16 v[212:213], v242 offset:45056
    ds_read_b64_tr_b16 v[214:215], v242 offset:46080
    s_waitcnt vmcnt(7)
    v_mfma_f32_32x32x16_bf16 v[16:31], v[152:155], v[108:111], v[16:31]
    ds_read_b64_tr_b16 v[216:217], v241 offset:47104
    ds_read_b64_tr_b16 v[218:219], v241 offset:48128
    buffer_load_dwordx4 v[76:79], v228, s[28:31], s17 offen offset:3072 sc1
    v_mfma_f32_32x32x16_bf16 v[32:47], v[156:159], v[108:111], v[32:47]
    ds_read_b64_tr_b16 v[220:221], v242 offset:47104
    ds_read_b64_tr_b16 v[222:223], v242 offset:48128
    s_bitcmp1_b32 s64, 6
    s_cbranch_scc0 K_n6
K_nr6:
    s_waitcnt vmcnt(7)
    s_waitcnt lgkmcnt(13)
    v_mfma_f32_32x32x16_bf16 v[16:31], v[160:163], v[48:51], v[16:31]
    ds_read_b64_tr_b16 v[128:129], v241 offset:49152
    ds_read_b64_tr_b16 v[130:131], v241 offset:50176
    buffer_load_dwordx4 v[80:83], v228, s[28:31], s18 offen offset:0 sc1
    v_mfma_f32_32x32x16_bf16 v[32:47], v[164:167], v[48:51], v[32:47]
    ds_read_b64_tr_b16 v[132:133], v242 offset:49152
    ds_read_b64_tr_b16 v[134:135], v242 offset:50176
    s_waitcnt vmcnt(7)
    v_mfma_f32_32x32x16_bf16 v[16:31], v[168:171], v[52:55], v[16:31]
    ds_read_b64_tr_b16 v[136:137], v241 offset:51200
    ds_read_b64_tr_b16 v[138:139], v241 offset:52224
    buffer_load_dwordx4 v[84:87], v228, s[28:31], s18 offen offset:1024 sc1
    v_mfma_f32_32x32x16_bf16 v[32:47], v[172:175], v[52:55], v[32:47]
    ds_read_b64_tr_b16 v[140:141], v242 offset:51200
    ds_read_b64_tr_b16 v[142:143], v242 offset:52224
    s_waitcnt vmcnt(7)
    v_mfma_f32_32x32x16_bf16 v[16:31], v[176:179], v[56:59], v[16:31]
    ds_read_b64_tr_b16 v[144:145], v241 offset:53248
    ds_read_b64_tr_b16 v[146:147], v241 offset:54272
    buffer_load_dwordx4 v[88:91], v228, s[28:31], s18 offen offset:2048 sc1
    v_mfma_f32_32x32x16_bf16 v[32:47], v[180:183], v[56:59], v[32:47]
    ds_read_b64_tr_b16 v[148:149], v242 offset:53248
    ds_read_b64_tr_b16 v[150:151], v242 offset:54272
    s_waitcnt vmcnt(7)
    v_mfma_f32_32x32x16_bf16 v[16:31], v[184:187], v[60:63], v[16:31]
    ds_read_b64_tr_b16 v[152:153], v241 offset:55296
    ds_read_b64_tr_b16 v[154:155], v241 offset:56320
    buffer_load_dwordx4 v[92:95], v228, s[28:31], s18 offen offset:3072 sc1
    v_mfma_f32_32x32x16_bf16 v[32:47], v[188:191], v[60:63], v[32:47]
    ds_read_b64_tr_b16 v[156:157], v242 offset:55296
    ds_read_b64_tr_b16 v[158:159], v242 offset:56320
    s_bitcmp1_b32 s64, 7
    s_cbranch_scc0 K_n7
K_nr7:
    s_waitcnt vmcnt(7)
    s_waitcnt lgkmcnt(13)
    v_mfma_f32_32x32x16_bf16 v[16:31], v[192:195], v[64:67], v[16:31]
    ds_read_b64_tr_b16 v[160:161], v241 offset:57344
    ds_read_b64_tr_b16 v[162:163], v241 offset:58368
    buffer_load_dwordx4 v[96:99], v228, s[28:31], s19 offen offset:0 sc1
    v_mfma_f32_32x32x16_bf16 v[32:47], v[196:199], v[64:67], v[32:47]
    ds_read_b64_tr_b16 v[164:165], v242 offset:57344
    ds_read_b64_tr_b16 v[166:167], v242 offset:58368
    s_waitcnt vmcnt(7)
    v_mfma_f32_32x32x16_bf16 v[16:31], v[200:203], v[68:71], v[16:31]
    ds_read_b64_tr_b16 v[168:169], v241 offset:59392
    ds_read_b64_tr_b16 v[170:171], v241 offset:60416
    buffer_load_dwordx4 v[100:103], v228, s[28:31], s19 offen offset:1024 sc1
    v_mfma_f32_32x32x16_bf16 v[32:47], v[204:207], v[68:71], v[32:47]
    ds_read_b64_tr_b16 v[172:173], v242 offset:59392
    ds_read_b64_tr_b16 v[174:175], v242 offset:60416
    s_waitcnt vmcnt(7)
    v_mfma_f32_32x32x16_bf16 v[16:31], v[208:211], v[72:75], v[16:31]
    ds_read_b64_tr_b16 v[176:177], v241 offset:61440
    ds_read_b64_tr_b16 v[178:179], v241 offset:62464
    buffer_load_dwordx4 v[104:107], v228, s[28:31], s19 offen offset:2048 sc1
    v_mfma_f32_32x32x16_bf16 v[32:47], v[212:215], v[72:75], v[32:47]
    ds_read_b64_tr_b16 v[180:181], v242 offset:61440
    ds_read_b64_tr_b16 v[182:183], v242 offset:62464
    s_waitcnt vmcnt(7)
    v_mfma_f32_32x32x16_bf16 v[16:31], v[216:219], v[76:79], v[16:31]
    ds_read_b64_tr_b16 v[184:185], v241 offset:63488
    ds_read_b64_tr_b16 v[186:187], v241 offset:64512
    buffer_load_dwordx4 v[108:111], v228, s[28:31], s19 offen offset:3072 sc1
    v_mfma_f32_32x32x16_bf16 v[32:47], v[220:223], v[76:79], v[32:47]
    ds_read_b64_tr_b16 v[188:189], v242 offset:63488
    ds_read_b64_tr_b16 v[190:191], v242 offset:64512
    s_waitcnt vmcnt(7)
    s_waitcnt lgkmcnt(13)
    v_mfma_f32_32x32x16_bf16 v[16:31], v[128:131], v[80:83], v[16:31]
    v_mfma_f32_32x32x16_bf16 v[32:47], v[132:135], v[80:83], v[32:47]
    s_waitcnt vmcnt(6)
    v_mfma_f32_32x32x16_bf16 v[16:31], v[136:139], v[84:87], v[16:31]
    v_mfma_f32_32x32x16_bf16 v[32:47], v[140:143], v[84:87], v[32:47]
    s_waitcnt vmcnt(5)
    v_mfma_f32_32x32x16_bf16 v[16:31], v[144:147], v[88:91], v[16:31]
    v_mfma_f32_32x32x16_bf16 v[32:47], v[148:151], v[88:91], v[32:47]
    s_waitcnt vmcnt(4)
    v_mfma_f32_32x32x16_bf16 v[16:31], v[152:155], v[92:95], v[16:31]
    v_mfma_f32_32x32x16_bf16 v[32:47], v[156:159], v[92:95], v[32:47]
    s_waitcnt vmcnt(3)
    s_waitcnt lgkmcnt(12)
    v_mfma_f32_32x32x16_bf16 v[16:31], v[160:163], v[96:99], v[16:31]
    v_mfma_f32_32x32x16_bf16 v[32:47], v[164:167], v[96:99], v[32:47]
    s_waitcnt vmcnt(2)
    s_waitcnt lgkmcnt(8)
    v_mfma_f32_32x32x16_bf16 v[16:31], v[168:171], v[100:103], v[16:31]
    v_mfma_f32_32x32x16_bf16 v[32:47], v[172:175], v[100:103], v[32:47]
    s_waitcnt vmcnt(1)
    s_waitcnt lgkmcnt(4)
    v_mfma_f32_32x32x16_bf16 v[16:31], v[176:179], v[104:107], v[16:31]
    v_mfma_f32_32x32x16_bf16 v[32:47], v[180:183], v[104:107], v[32:47]
    s_waitcnt vmcnt(0)
    s_waitcnt lgkmcnt(0)
    v_mfma_f32_32x32x16_bf16 v[16:31], v[184:187], v[108:111], v[16:31]
    v_mfma_f32_32x32x16_bf16 v[32:47], v[188:191], v[108:111], v[32:47]
    s_nop 10
    v_cvt_pk_bf16_f32 v48, v16, v17
    v_cvt_pk_bf16_f32 v49, v18, v19
    v_cvt_pk_bf16_f32 v50, v20, v21
    v_cvt_pk_bf16_f32 v51, v22, v23
    v_xor_b32 v10, 0, v231
    ds_write_b128 v10, v[48:51]
    v_cvt_pk_bf16_f32 v52, v24, v25
    v_cvt_pk_bf16_f32 v53, v26, v27
    v_cvt_pk_bf16_f32 v54, v28, v29
    v_cvt_pk_bf16_f32 v55, v30, v31
    v_xor_b32 v10, 16, v231
    ds_write_b128 v10, v[52:55]
    v_cvt_pk_bf16_f32 v56, v32, v33
    v_cvt_pk_bf16_f32 v57, v34, v35
    v_cvt_pk_bf16_f32 v58, v36, v37
    v_cvt_pk_bf16_f32 v59, v38, v39
    v_xor_b32 v10, 32, v231
    ds_write_b128 v10, v[56:59]
    v_cvt_pk_bf16_f32 v60, v40, v41
    v_cvt_pk_bf16_f32 v61, v42, v43
    v_cvt_pk_bf16_f32 v62, v44, v45
    v_cvt_pk_bf16_f32 v63, v46, v47
    v_xor_b32 v10, 48, v231
    ds_write_b128 v10, v[60:63]
    ds_read_b128 v[64:67], v232 offset:0
    ds_read_b128 v[68:71], v232 offset:1024
    ds_read_b128 v[72:75], v232 offset:2048
    ds_read_b128 v[76:79], v232 offset:3072
    s_add_u32 s8, s49, 0
    s_waitcnt lgkmcnt(3)
    buffer_store_dwordx4 v[64:67], v243, s[24:27], s8 offen sc1
    s_add_u32 s8, s49, 16384
    s_waitcnt lgkmcnt(2)
    buffer_store_dwordx4 v[68:71], v243, s[24:27], s8 offen sc1
    s_add_u32 s8, s49, 32768
    s_waitcnt lgkmcnt(1)
    buffer_store_dwordx4 v[72:75], v243, s[24:27], s8 offen sc1
    s_add_u32 s8, s49, 49152
    s_waitcnt lgkmcnt(0)
    buffer_store_dwordx4 v[76:79], v243, s[24:27], s8 offen sc1
    s_branch K_end
K_n1:
    buffer_load_dword v10, v237, s[28:31], s38 offen sc1
    s_add_u32 s65, s65, 1
    s_waitcnt vmcnt(0)
    v_cmp_eq_u32 vcc, v117, v10
    s_cmp_ge_u32 s65, 16384
    s_cselect_b32 s64, -1, vcc_lo
    s_bitcmp1_b32 s64, 1
    s_cbranch_scc0 K_n1
    s_branch K_nr1
K_n2:
    buffer_load_dword v10, v237, s[28:31], s38 offen sc1
    s_add_u32 s65, s65, 1
    s_waitcnt vmcnt(0)
    v_cmp_eq_u32 vcc, v117, v10
    s_cmp_ge_u32 s65, 16384
    s_cselect_b32 s64, -1, vcc_lo
    s_bitcmp1_b32 s64, 2
    s_cbranch_scc0 K_n2
    s_branch K_nr2
K_n3:
    buffer_load_dword v10, v237, s[28:31], s38 offen sc1
    s_add_u32 s65, s65, 1
    s_waitcnt vmcnt(0)
    v_cmp_eq_u32 vcc, v117, v10
    s_cmp_ge_u32 s65, 16384
    s_cselect_b32 s64, -1, vcc_lo
    s_bitcmp1_b32 s64, 3
    s_cbranch_scc0 K_n3
    s_branch K_nr3
K_n4:
    buffer_load_dword v10, v237, s[28:31], s38 offen sc1
    s_add_u32 s65, s65, 1
    s_waitcnt vmcnt(0)
    v_cmp_eq_u32 vcc, v117, v10
    s_cmp_ge_u32 s65, 16384
    s_cselect_b32 s64, -1, vcc_lo
    s_bitcmp1_b32 s64, 4
    s_cbranch_scc0 K_n4
    s_branch K_nr4
K_n5:
    buffer_load_dword v10, v237, s[28:31], s38 offen sc1
    s_add_u32 s65, s65, 1
    s_waitcnt vmcnt(0)
    v_cmp_eq_u32 vcc, v117, v10
    s_cmp_ge_u32 s65, 16384
    s_cselect_b32 s64, -1, vcc_lo
    s_bitcmp1_b32 s64, 5
    s_cbranch_scc0 K_n5
    s_branch K_nr5
K_n6:
    buffer_load_dword v10, v237, s[28:31], s38 offen sc1
    s_add_u32 s65, s65, 1
    s_waitcnt vmcnt(0)
    v_cmp_eq_u32 vcc, v117, v10
    s_cmp_ge_u32 s65, 16384
    s_cselect_b32 s64, -1, vcc_lo
    s_bitcmp1_b32 s64, 6
    s_cbranch_scc0 K_n6
    s_branch K_nr6
K_n7:
    buffer_load_dword v10, v237, s[28:31], s38 offen sc1
    s_add_u32 s65, s65, 1
    s_waitcnt vmcnt(0)
    v_cmp_eq_u32 vcc, v117, v10
    s_cmp_ge_u32 s65, 16384
    s_cselect_b32 s64, -1, vcc_lo
    s_bitcmp1_b32 s64, 7
    s_cbranch_scc0 K_n7
    s_branch K_nr7
K_end:
    s_endpgm
.section .rodata,"a"
.p2align 6
.amdhsa_kernel concat_heads__linear_kernel_hedgehog__linear_kernel_hedgehog__prompt_kernel
  .amdhsa_next_free_vgpr 256
  .amdhsa_next_free_sgpr 102
  .amdhsa_accum_offset 256
  .amdhsa_group_segment_fixed_size 0
  .amdhsa_kernarg_size 88
  .amdhsa_user_sgpr_count 2
  .amdhsa_user_sgpr_kernarg_segment_ptr 1
  .amdhsa_system_sgpr_workgroup_id_x 1
.end_amdhsa_kernel
```
